```python
import torch

def _softmax(x, axis=-1):
    return torch.softmax(x, dim=axis)
def _gelu(x):
    return torch.nn.functional.gelu(x, approximate="tanh")
def _silu(x):
    return torch.nn.functional.silu(x)
def _sigmoid(x):
    return torch.sigmoid(x)
def _layernorm(x, axis=-1, eps=1e-5):
    m = x.mean(dim=axis, keepdim=True)
    v = x.var(dim=axis, keepdim=True, unbiased=False)
    return (x - m) / torch.sqrt(v + eps)
def _scatter_add(tgt, idx, src, axis=0):
    return tgt.clone().index_add_(axis, idx, src)
def _segment_sum(src, seg, n):
    out = torch.zeros((n,) + src.shape[1:], dtype=src.dtype)
    return out.index_add_(0, seg, src)
def _pad(x, pw):
    flat = tuple(v for pair in reversed(pw) for v in pair)
    return torch.nn.functional.pad(x, flat)

kernel_name = 'concat_heads__ssm_conv_s4__softmax_full_mha__prompt'

def setup_inputs():

    _w = (lambda a: (lambda t: t.to(torch.bfloat16) if t.is_floating_point() else t)(torch.as_tensor(a)))
    def _A_setup():
        B, L, D, N = 1, 2048, 448, 256
        A_re = -(lambda _x: torch.exp(torch.as_tensor(_x)))((lambda *s: torch.randn(*s, dtype=torch.bfloat16) * 3.2)(D, N))
        A_im = torch.pi * (lambda *s: torch.randn(*s, dtype=torch.bfloat16) * 0.05)(D, N)
        B_re = (lambda *s: torch.randn(*s, dtype=torch.bfloat16) * 0.2)(D, N)
        B_im = (lambda *s: torch.randn(*s, dtype=torch.bfloat16) * 0.2)(D, N)
        C_re = (lambda *s: torch.randn(*s, dtype=torch.bfloat16) * 0.2)(D, N)
        C_im = (lambda *s: torch.randn(*s, dtype=torch.bfloat16) * 0.2)(D, N)
        log_dt = (lambda *s: torch.randn(*s, dtype=torch.bfloat16) * 0.05)(D) * 0.5 - 4.0
        Dskip = (lambda *s: torch.randn(*s, dtype=torch.bfloat16) * 0.1)(D)
        return {
            "u": _w((lambda *s: torch.randn(*s, dtype=torch.bfloat16) * 0.05)(B, L, D)),
            "A_re": _w(A_re),
            "A_im": _w(A_im),
            "B_re": _w(B_re),
            "B_im": _w(B_im),
            "C_re": _w(C_re),
            "C_im": _w(C_im),
            "log_dt": _w(log_dt),
            "Dskip": _w(Dskip),
        }
    _A_in = _A_setup()

    def _B_setup():
        B, S, D = 1, 2048, 448
        return {
            "x": _w((lambda *s: torch.randn(*s, dtype=torch.bfloat16) * 0.2)(B, S, D)),
            "wqkv": _w((lambda *s: torch.randn(*s, dtype=torch.bfloat16) * 0.2)(D, 3 * D)),
            "wo": _w((lambda *s: torch.randn(*s, dtype=torch.bfloat16) * 0.05)(D, D)),
        }
    _B_in = _B_setup()

    return {
        "A_u": _A_in["u"],
        "A_A_re": _A_in["A_re"],
        "A_A_im": _A_in["A_im"],
        "A_B_re": _A_in["B_re"],
        "A_B_im": _A_in["B_im"],
        "A_C_re": _A_in["C_re"],
        "A_C_im": _A_in["C_im"],
        "A_log_dt": _A_in["log_dt"],
        "A_Dskip": _A_in["Dskip"],
        "B_x": _B_in["x"],
        "B_wqkv": _B_in["wqkv"],
        "B_wo": _B_in["wo"],
    }

def reference(A_u, A_A_re, A_A_im, A_B_re, A_B_im, A_C_re, A_C_im, A_log_dt, A_Dskip, B_x, B_wqkv, B_wo):
    def _A_ref(u, A_re, A_im, B_re, B_im, C_re, C_im, log_dt, Dskip):
        Bsz, L, D = u.shape
        dt = torch.exp(log_dt)[:, None]
        A = A_re + 1j * A_im
        Bc = B_re + 1j * B_im
        Cc = C_re + 1j * C_im
        logdA = dt * A
        dB = dt * Bc
        l = (lambda x, dt: x.to(dt))(torch.arange(L), A_re.dtype)
        P = torch.exp(logdA[:, :, None] * l[None, None, :])
        K = torch.einsum("dn,dnl,dn->dl", Cc, P, dB).real
        L2 = 2 * L
        Kp = _pad(K, ((0, 0), (0, L)))
        up = (lambda x, *d: x.permute(*d))(u, 0, 2, 1)
        up = _pad(up, ((0, 0), (0, 0), (0, L)))
        Kf = (lambda x, axes=(-2,-1): torch.fft.rfft2(x.float(), dim=axes))(Kp[:, None, :], axes=(-2, -1))
        Uf = (lambda x, axes=(-2,-1): torch.fft.rfft2(x.float(), dim=axes))(up[:, :, None, :], axes=(-2, -1))
        Yf = Uf * Kf[None, :, :, :]
        y = (lambda x, s, axes=(-2,-1): torch.fft.irfft2(x, s=s, dim=axes).to(torch.bfloat16))(Yf, (1, L2), axes=(-2, -1))[:, :, 0, :L]
        y = (lambda x, *d: x.permute(*d))(y, 0, 2, 1) + u * Dskip[None, None, :]
        return y

    def _B_ref(x, wqkv, wo):
        B, S, D = x.shape
        H = 16; Dh = D // H
        qkv = (lambda x, *d: x.permute(*d))((x @ wqkv).reshape(B, S, 3, H, Dh), 2, 0, 3, 1, 4)
        q, k, v = qkv[0], qkv[1], qkv[2]
        scale = Dh ** -0.5
        scores = torch.einsum("bhqd,bhkd->bhqk", q, k) * scale
        p = _softmax(scores, axis=-1)
        o = torch.einsum("bhqk,bhkd->bhqd", p, v)
        return (lambda x, *d: x.permute(*d))(o, 0, 2, 1, 3).reshape(B, S, D) @ wo

    a = _A_ref(A_u, A_A_re, A_A_im, A_B_re, A_B_im, A_C_re, A_C_im, A_log_dt, A_Dskip)
    b = _B_ref(B_x, B_wqkv, B_wo)
    return torch.concatenate([a, b], axis=-1)
```

```asm
; @launch grid=(256,1,1) block=(512,1,1) lds=163840
.amdgcn_target "amdgcn-amd-amdhsa--gfx950"
.text
.globl concat_heads__ssm_conv_s4__softmax_full_mha__prompt_kernel
.p2align 12
.p2align 8
.type concat_heads__ssm_conv_s4__softmax_full_mha__prompt_kernel,@function
concat_heads__ssm_conv_s4__softmax_full_mha__prompt_kernel:
  s_cmp_ge_u32 s2, 256
  s_cbranch_scc1 Lend
  s_load_dwordx8 s[48:55], s[0:1], 64
  s_load_dwordx16 s[32:47], s[0:1], 0
  s_load_dwordx2 s[60:61], s[0:1], 112
  s_load_dwordx4 s[56:59], s[0:1], 96
  v_lshrrev_b32 v1, 6, v0
  v_and_b32 v0, 63, v0
  v_mov_b32 v13, 162828
  v_mov_b32 v16, 0
  v_lshl_add_u32 v3, v0, 4, v13
  ds_write_b32 v3, v16
  s_barrier
  s_and_b32 s6, s2, 7
  v_readfirstlane_b32 s3, v1
  s_lshr_b32 s7, s2, 3
  s_mul_i32 s63, s7, 37
  s_lshr_b32 s63, s63, 8
  s_mul_i32 s64, s63, 7
  s_sub_u32 s64, s7, s64
  s_cmp_ge_u32 s7, 28
  s_cselect_b32 s4, 7, s64
  s_cselect_b32 s5, s64, s63
  s_and_b32 s63, s6, 1
  s_lshl_b32 s64, s63, 3
  s_add_u32 s4, s4, s64
  s_sub_u32 s66, s4, s63
  s_lshr_b32 s63, s6, 1
  s_lshl_b32 s63, s63, 2
  s_add_u32 s5, s5, s63
  v_lshrrev_b32 v1, 3, v0
  v_and_b32 v2, 7, v0
  s_mov_b32 s10, 1835008
  s_mov_b32 s11, 0x20000
  s_cmp_lt_u32 s3, 4
  s_cbranch_scc1 Lb_head
  s_setprio 3
  s_sub_u32 s3, s3, 4
  s_andn2_b32 s63, s7, 3
  s_mul_i32 s63, s63, 7
  s_add_u32 s63, s63, 28
  s_lshl_b32 s68, s6, 5
  s_cmp_eq_u32 s6, 7
  s_cselect_b32 s68, s63, s68
  s_add_u32 s68, s68, s7
  s_mov_b32 s69, s68
  s_lshl_b32 s64, s69, 10
  s_lshl_b32 s65, s3, 8
  s_add_u32 s64, s64, s65
  v_lshl_add_u32 v27, v0, 2, s64
  s_lshl_b32 s69, s69, 2
  s_cmp_lt_u32 s7, 28
  s_cbranch_scc1 La_nt
  s_cmp_eq_u32 s3, 0
  s_cbranch_scc1 Lh_P4
  s_branch La_t
La_nt:
  s_waitcnt lgkmcnt(0)
  s_load_dword s50, s[46:47], s69
  global_load_dword v20, v27, s[34:35]
  global_load_dword v21, v27, s[36:37]
  global_load_dword v22, v27, s[38:39]
  global_load_dword v23, v27, s[40:41]
  global_load_dword v24, v27, s[42:43]
  global_load_dword v25, v27, s[44:45]
  s_load_dword s62, s[60:61], 0
  s_load_dword s31, s[48:49], s69
  s_setprio 0
  s_cmp_eq_u32 s3, 1
  s_cbranch_scc1 Lh_P1
  s_branch La_head
Lb_head:
  v_lshrrev_b32 v40, 4, v0
  v_xor_b32 v40, v40, v2
  v_mul_u32_u24 v41, 896, v1
  v_lshl_add_u32 v40, v40, 4, v41
  v_xor_b32 v41, 64, v40
  s_lshl_b32 s64, s5, 2
  s_add_u32 s68, s64, s3
  s_mul_i32 s28, s68, 28672
  s_add_u32 s29, s28, 7168
  s_add_u32 s30, s28, 14336
  s_add_u32 s31, s28, 21504
  v_bfe_u32 v3, v0, 4, 1
  v_lshlrev_b32 v3, 2, v3
  v_xor_b32 v3, v3, v2
  v_mul_u32_u24 v4, 2688, v1
  v_lshl_add_u32 v4, v3, 4, v4
  v_add_u32 v42, 21504, v4
  s_mul_i32 s64, s3, 43008
  s_add_u32 s26, s66, 7
  s_lshl_b32 s26, s26, 7
  s_add_u32 s26, s26, s64
  s_mul_i32 s25, s3, 12288
  s_add_u32 s25, s25, 57344
  s_lshl_b32 s24, s3, 11
  s_mov_b32 m0, s24
  s_mov_b32 s15, 0x20000
  s_cmp_ge_u32 s7, 28
  s_cselect_b32 s14, 0, 1204224
  s_setprio 2
  s_waitcnt lgkmcnt(0)
  s_mov_b32 s12, s52
  s_mov_b32 s13, s53
  buffer_load_dwordx4 v4, s[12:15], s26 offen lds
  s_add_u32 m0, s24, 1024
  s_nop 0
  buffer_load_dwordx4 v42, s[12:15], s26 offen lds
  s_add_u32 s26, s26, 172032
  s_mov_b32 s8, s50
  s_mov_b32 s9, s51
  s_add_u32 m0, s25, 0
  s_nop 0
  buffer_load_dwordx4 v40, s[8:11], s28 offen offset:0 lds
  s_add_u32 m0, s25, 1024
  s_nop 0
  buffer_load_dwordx4 v41, s[8:11], s29 offen offset:0 lds
  s_load_dword s62, s[60:61], 0
  s_add_u32 m0, s25, 2048
  s_nop 0
  buffer_load_dwordx4 v40, s[8:11], s30 offen offset:0 lds
  s_add_u32 m0, s25, 3072
  s_nop 0
  buffer_load_dwordx4 v41, s[8:11], s31 offen offset:0 lds
  s_add_u32 m0, s24, 8192
  s_nop 0
  buffer_load_dwordx4 v4, s[12:15], s26 offen lds
  s_add_u32 m0, s24, 9216
  s_nop 0
  buffer_load_dwordx4 v42, s[12:15], s26 offen lds
  s_add_u32 s26, s26, 172032
  s_setprio 2
Lb_cont:
  v_lshlrev_b32 v18, 4, v0
  v_mov_b32 v20, 0
  v_add_u32 v3, s25, v18
  v_and_b32 v14, 31, v0
  v_bfe_u32 v5, v0, 1, 3
  v_lshrrev_b32 v15, 5, v0
  v_xor_b32 v5, v5, v15
  v_lshlrev_b32 v5, 4, v5
  v_lshl_add_u32 v5, v14, 7, v5
  v_add_u32 v5, s25, v5
  v_xor_b32 v6, 32, v5
  v_xor_b32 v7, 64, v5
  v_xor_b32 v8, 0x60, v5
  s_mul_i32 s67, s4, 7
  s_lshr_b32 s67, s67, 1
  s_mul_i32 s65, s3, 301056
  s_lshl_b32 s27, s67, 4
  s_add_u32 s27, s27, s65
  s_add_u32 s20, s60, 1048576
  s_addc_u32 s21, s61, 0
  s_mov_b32 s22, 3784704
  s_mov_b32 s23, 0x20000
  s_mul_i32 s32, s68, 59136
  s_lshl_b32 s63, s66, 7
  s_add_u32 s69, s32, s63
  s_add_u32 s69, s69, 42112
  s_cmp_lt_u32 s66, 7
  s_cselect_b32 s69, 0x40000000, s69
  s_cmp_ge_u32 s7, 28
  s_cselect_b32 s69, 0x40000000, s69
  v_mul_u32_u24 v31, 15232, v0
  v_mov_b32 v104, 0x3f803f80
  v_mov_b32 v105, 0x3f803f80
  v_mov_b32 v106, 0x3f803f80
  v_mov_b32 v107, 0x3f803f80
  s_mov_b64 exec, 3
  buffer_store_dwordx4 v[104:107], v31, s[20:23], s69 offen sc1
  s_mov_b64 exec, -1
  s_mov_b32 s16, s60
  s_mov_b32 s17, s61
  s_mov_b32 s18, 16777216
  s_mov_b32 s19, 0x20000
  v_and_b32 v19, 1, v0
  v_lshlrev_b32 v16, 4, v19
  v_and_b32 v19, 2, v0
  v_lshl_add_u32 v16, v19, 2, v16
  v_and_b32 v19, 16, v0
  v_lshl_add_u32 v16, v19, 1, v16
  v_bfe_u32 v17, v0, 2, 2
  v_lshrrev_b32 v21, 5, v0
  v_lshl_add_u32 v19, v21, 3, v17
  v_lshl_add_u32 v9, v19, 7, v16
  v_lshrrev_b32 v21, 1, v17
  v_lshl_add_u32 v9, v21, 6, v9
  v_xor_b32 v10, 64, v9
  v_lshl_add_u32 v11, v19, 6, v16
  v_add_u32 v11, 61440, v11
  v_mov_b32 v12, 1
  v_lshrrev_b32 v16, 2, v0
  v_and_b32 v17, 3, v0
  v_mul_u32_u24 v16, 2688, v16
  v_lshl_add_u32 v16, v17, 4, v16
  s_lshr_b32 s63, s67, 3
  s_add_u32 s64, s67, 3
  s_lshr_b32 s64, s64, 3
  s_lshl_b32 s64, s64, 8
  s_or_b32 s63, s63, s64
  s_mul_i32 s65, s4, 28
  s_lshr_b32 s64, s65, 6
  s_add_u32 s64, s64, 7
  s_lshl_b32 s64, s64, 16
  s_or_b32 s63, s63, s64
  s_add_u32 s64, s65, 27
  s_lshr_b32 s64, s64, 6
  s_add_u32 s64, s64, 7
  s_lshl_b32 s64, s64, 24
  s_or_b32 s63, s63, s64
  v_lshrrev_b32 v22, 4, v0
  v_lshlrev_b32 v22, 3, v22
  v_lshrrev_b32 v22, v22, s63
  v_and_b32 v22, 15, v22
  v_and_b32 v23, 15, v0
  v_lshl_add_u32 v22, v22, 6, v23
  s_lshl_b32 s63, s3, 11
  s_add_u32 s63, s63, 393216
  v_lshl_add_u32 v22, v22, 7, s63
  s_lshl_b32 s64, s66, 6
  s_add_u32 s64, s64, s5
  s_lshl_b32 s64, s64, 7
  s_add_u32 s34, s63, s64
  s_lshl_b32 s63, s67, 9
  v_and_b32 v19, 0x33, v0
  v_and_b32 v23, 4, v0
  v_lshl_add_u32 v19, v23, 1, v19
  v_bfe_u32 v23, v0, 3, 1
  v_lshl_add_u32 v19, v23, 2, v19
  v_lshl_add_u32 v24, v19, 4, s63
  v_bfe_u32 v25, v0, 4, 1
  v_bfe_u32 v26, v0, 2, 1
  v_lshl_add_u32 v25, v25, 1, v26
  v_mul_u32_u24 v25, 7, v25
  v_bfe_u32 v26, v0, 3, 1
  v_lshl_add_u32 v25, v26, 2, v25
  v_and_b32 v26, 3, v0
  v_add3_u32 v25, v25, v26, s65
  v_mul_u32_u24 v26, 7168, v15
  v_lshl_add_u32 v25, v25, 4, v26
  v_add_u32 v30, 28672, v25
  s_lshr_b32 s63, s65, 6
  s_lshl_b32 s63, s63, 7
  s_add_u32 s63, s63, 43008
  s_mov_b32 exec_lo, 0x88008800
  s_mov_b32 exec_hi, 0x88008800
  v_mov_b32 v30, s63
  s_mov_b64 exec, -1
  s_mov_b32 s65, 0x3e8b97f6
  s_and_b32 s63, s4, 1
  v_mov_b32 v27, s65
  v_mov_b32 v28, s65
  v_cmp_gt_u32 vcc, s63, v15
  s_nop 1
  v_cndmask_b32 v27, v27, v20, vcc
  v_cmp_lt_u32 vcc, s63, v15
  s_nop 1
  v_cndmask_b32 v28, v28, v20, vcc
  v_mov_b32 v29, s65
  v_mul_u32_u24 v23, 6656, v15
  v_lshl_add_u32 v19, v19, 4, v23
  s_lshl_b32 s64, s66, 10
  s_add_u32 s64, s64, 21504
  s_lshl_b32 s65, s66, 12
  s_cmp_ge_u32 s66, 7
  s_cselect_b32 s64, s64, s65
  s_movk_i32 s65, 1024
  s_cselect_b32 s33, 15232, s65
  s_add_u32 s32, s32, s64
  s_add_u32 s33, s33, s32
  s_mov_b32 s36, 0x3ffff
  s_add_u32 m0, s25, 3968
  s_nop 0
  buffer_load_dwordx4 v40, s[8:11], s28 offen offset:128 lds
  s_add_u32 m0, s25, 4992
  s_nop 0
  buffer_load_dwordx4 v41, s[8:11], s29 offen offset:128 lds
  s_add_u32 m0, s25, 6016
  s_nop 0
  buffer_load_dwordx4 v40, s[8:11], s30 offen offset:128 lds
  s_add_u32 m0, s25, 7040
  s_nop 0
  buffer_load_dwordx4 v41, s[8:11], s31 offen offset:128 lds
  s_add_u32 m0, s24, 16384
  s_nop 0
  buffer_load_dwordx4 v4, s[12:15], s26 offen lds
  s_add_u32 m0, s24, 17408
  s_nop 0
  buffer_load_dwordx4 v42, s[12:15], s26 offen lds
  s_add_u32 s26, s26, 172032
  s_add_u32 m0, s24, 24576
  s_nop 0
  buffer_load_dwordx4 v4, s[12:15], s26 offen lds
  s_add_u32 m0, s24, 25600
  s_nop 0
  buffer_load_dwordx4 v42, s[12:15], s26 offen lds
  s_add_u32 s26, s26, 172032
  s_add_u32 m0, s25, 7936
  s_nop 0
  buffer_load_dwordx4 v40, s[8:11], s28 offen offset:256 lds
  s_add_u32 m0, s25, 8960
  s_nop 0
  buffer_load_dwordx4 v41, s[8:11], s29 offen offset:256 lds
  s_add_u32 m0, s25, 9984
  s_nop 0
  buffer_load_dwordx4 v40, s[8:11], s30 offen offset:256 lds
  s_add_u32 m0, s25, 11008
  s_nop 0
  buffer_load_dwordx4 v41, s[8:11], s31 offen offset:256 lds
  s_waitcnt lgkmcnt(0)
  s_mul_i32 s62, s62, 0x9E3779B1
  s_add_u32 s62, s62, 0x7F4A7C15
  s_or_b32 s62, s62, 1
  v_mov_b32 v21, s62
  s_waitcnt vmcnt(15)
  ds_read_b128 v[144:147], v5 offset:0
  ds_read_b128 v[148:151], v6 offset:0
  ds_read_b128 v[152:155], v7 offset:0
  ds_read_b128 v[156:159], v8 offset:0
  s_add_u32 m0, s24, 32768
  s_nop 0
  buffer_load_dwordx4 v4, s[12:15], s26 offen lds
  s_add_u32 m0, s24, 33792
  s_nop 0
  buffer_load_dwordx4 v42, s[12:15], s26 offen lds
  s_add_u32 s26, s26, 172032
  s_waitcnt lgkmcnt(0)
  s_add_u32 m0, s25, -384
  s_nop 0
  buffer_load_dwordx4 v40, s[8:11], s28 offen offset:384 lds
  s_add_u32 m0, s25, 640
  s_nop 0
  buffer_load_dwordx4 v41, s[8:11], s29 offen offset:384 lds
  s_add_u32 m0, s25, 1664
  s_nop 0
  buffer_load_dwordx4 v40, s[8:11], s30 offen offset:384 lds
  s_add_u32 m0, s25, 2688
  s_nop 0
  buffer_load_dwordx4 v41, s[8:11], s31 offen offset:384 lds
  s_waitcnt vmcnt(14)
  ds_read_b128 v[160:163], v5 offset:4096
  ds_read_b128 v[164:167], v6 offset:4096
  ds_read_b128 v[168:171], v7 offset:4096
  ds_read_b128 v[172:175], v8 offset:4096
  s_add_u32 m0, s24, 40960
  s_nop 0
  buffer_load_dwordx4 v4, s[12:15], s26 offen lds
  s_add_u32 m0, s24, 41984
  s_nop 0
  buffer_load_dwordx4 v42, s[12:15], s26 offen lds
  s_add_u32 s26, s26, 172032
  s_waitcnt lgkmcnt(0)
  s_add_u32 m0, s25, 3584
  s_nop 0
  buffer_load_dwordx4 v40, s[8:11], s28 offen offset:512 lds
  s_add_u32 m0, s25, 4608
  s_nop 0
  buffer_load_dwordx4 v41, s[8:11], s29 offen offset:512 lds
  s_add_u32 m0, s25, 5632
  s_nop 0
  buffer_load_dwordx4 v40, s[8:11], s30 offen offset:512 lds
  s_add_u32 m0, s25, 6656
  s_nop 0
  buffer_load_dwordx4 v41, s[8:11], s31 offen offset:512 lds
  s_waitcnt vmcnt(12)
  s_mov_b64 exec, 1
  ds_add_u32 v13, v12 offset:0
  s_mov_b64 exec, -1
  ds_read_b128 v[176:179], v5 offset:8192
  ds_read_b128 v[180:183], v6 offset:8192
  ds_read_b128 v[184:187], v7 offset:8192
  ds_read_b128 v[188:191], v8 offset:8192
  s_add_u32 m0, s24, 49152
  s_nop 0
  buffer_load_dwordx4 v4, s[12:15], s26 offen lds
  s_add_u32 m0, s24, 50176
  s_nop 0
  buffer_load_dwordx4 v42, s[12:15], s26 offen lds
  s_waitcnt lgkmcnt(0)
  s_add_u32 m0, s25, 7552
  s_nop 0
  buffer_load_dwordx4 v40, s[8:11], s28 offen offset:640 lds
  s_add_u32 m0, s25, 8576
  s_nop 0
  buffer_load_dwordx4 v41, s[8:11], s29 offen offset:640 lds
  s_add_u32 m0, s25, 9600
  s_nop 0
  buffer_load_dwordx4 v40, s[8:11], s30 offen offset:640 lds
  s_add_u32 m0, s25, 10624
  s_nop 0
  buffer_load_dwordx4 v41, s[8:11], s31 offen offset:640 lds
  s_waitcnt vmcnt(12)
  ds_read_b128 v[192:195], v5 offset:0
  ds_read_b128 v[196:199], v6 offset:0
  ds_read_b128 v[200:203], v7 offset:0
  ds_read_b128 v[204:207], v8 offset:0
  ds_read_b32 v23, v13 offset:0
  s_mov_b32 s14, 1204224
  s_waitcnt lgkmcnt(1)
  s_add_u32 m0, s25, -768
  s_nop 0
  buffer_load_dwordx4 v40, s[8:11], s28 offen offset:768 lds
  s_add_u32 m0, s25, 256
  s_nop 0
  buffer_load_dwordx4 v41, s[8:11], s29 offen offset:768 lds
  s_add_u32 m0, s25, 1280
  s_nop 0
  buffer_load_dwordx4 v40, s[8:11], s30 offen offset:768 lds
  s_add_u32 m0, s25, 2304
  s_nop 0
  buffer_load_dwordx4 v41, s[8:11], s31 offen offset:768 lds
  s_cmp_ge_u32 s7, 28
  s_cbranch_scc1 Lkv_t
  s_waitcnt lgkmcnt(0)
  v_readfirstlane_b32 s65, v23
  s_cmp_ge_u32 s65, 4
  s_cbranch_scc1 Lsx_2
  s_mov_b32 s64, 0
Lsp_1:
  ds_read_b32 v23, v13 offset:0
  s_add_u32 s64, s64, 1
  s_waitcnt lgkmcnt(0)
  v_readfirstlane_b32 s65, v23
  s_cmp_ge_u32 s65, 4
  s_cbranch_scc1 Lsx_2
  s_cmp_lt_u32 s64, 200000
  s_cbranch_scc1 Lsp_1
Lsx_2:
  s_setprio 2
  ds_read_b64_tr_b16 v[80:81], v9 offset:0
  ds_read_b64_tr_b16 v[82:83], v9 offset:512
  ds_read_b64_tr_b16 v[84:85], v10 offset:0
  ds_read_b64_tr_b16 v[86:87], v10 offset:512
  ds_read_b64_tr_b16 v[88:89], v9 offset:2048
  ds_read_b64_tr_b16 v[90:91], v9 offset:2560
  ds_read_b64_tr_b16 v[92:93], v10 offset:2048
  ds_read_b64_tr_b16 v[94:95], v10 offset:2560
  s_cmp_ge_u32 s66, 7
  s_cbranch_scc1 Lkv_v
Lkv_k:
  s_waitcnt lgkmcnt(6)
  v_mfma_f32_32x32x16_bf16 v[48:63], v[80:83], v[144:147], 0
  ds_read_b64_tr_b16 v[96:97], v9 offset:4096
  ds_read_b64_tr_b16 v[98:99], v9 offset:4608
  s_waitcnt lgkmcnt(6)
  v_mfma_f32_32x32x16_bf16 v[64:79], v[84:87], v[144:147], 0
  ds_read_b64_tr_b16 v[100:101], v10 offset:4096
  ds_read_b64_tr_b16 v[102:103], v10 offset:4608
  s_waitcnt lgkmcnt(6)
  v_mfma_f32_32x32x16_bf16 v[48:63], v[88:91], v[148:151], v[48:63]
  ds_read_b64_tr_b16 v[80:81], v9 offset:6144
  ds_read_b64_tr_b16 v[82:83], v9 offset:6656
  s_waitcnt lgkmcnt(6)
  v_mfma_f32_32x32x16_bf16 v[64:79], v[92:95], v[148:151], v[64:79]
  ds_read_b64_tr_b16 v[84:85], v10 offset:6144
  ds_read_b64_tr_b16 v[86:87], v10 offset:6656
  s_waitcnt lgkmcnt(6)
  v_mfma_f32_32x32x16_bf16 v[48:63], v[96:99], v[152:155], v[48:63]
  ds_read_b64_tr_b16 v[88:89], v9 offset:8192
  ds_read_b64_tr_b16 v[90:91], v9 offset:8704
  s_waitcnt vmcnt(10)
  ds_read_b128 v[208:211], v5 offset:4096
  ds_read_b128 v[212:215], v6 offset:4096
  ds_read_b128 v[216:219], v7 offset:4096
  ds_read_b128 v[220:223], v8 offset:4096
  s_waitcnt lgkmcnt(10)
  v_mfma_f32_32x32x16_bf16 v[64:79], v[100:103], v[152:155], v[64:79]
  ds_read_b64_tr_b16 v[92:93], v10 offset:8192
  ds_read_b64_tr_b16 v[94:95], v10 offset:8704
  s_waitcnt lgkmcnt(10)
  v_mfma_f32_32x32x16_bf16 v[48:63], v[80:83], v[156:159], v[48:63]
  ds_read_b64_tr_b16 v[96:97], v9 offset:10240
  ds_read_b64_tr_b16 v[98:99], v9 offset:10752
  s_waitcnt lgkmcnt(4)
  s_add_u32 m0, s25, 4096
  s_nop 0
  buffer_load_dwordx4 v16, s[12:15], s27 offen lds
  s_add_u32 s27, s27, 43008
  v_mfma_f32_32x32x16_bf16 v[64:79], v[84:87], v[156:159], v[64:79]
  ds_read_b64_tr_b16 v[100:101], v10 offset:10240
  ds_read_b64_tr_b16 v[102:103], v10 offset:10752
  s_add_u32 m0, s25, 5120
  s_nop 0
  buffer_load_dwordx4 v16, s[12:15], s27 offen lds
  s_add_u32 s27, s27, 43008
  v_mfma_f32_32x32x16_bf16 v[48:63], v[88:91], v[160:163], v[48:63]
  ds_read_b64_tr_b16 v[80:81], v9 offset:12288
  ds_read_b64_tr_b16 v[82:83], v9 offset:12800
  s_add_u32 m0, s25, 6144
  s_nop 0
  buffer_load_dwordx4 v16, s[12:15], s27 offen lds
  s_add_u32 s27, s27, 43008
  s_waitcnt lgkmcnt(6)
  v_mfma_f32_32x32x16_bf16 v[64:79], v[92:95], v[160:163], v[64:79]
  ds_read_b64_tr_b16 v[84:85], v10 offset:12288
  ds_read_b64_tr_b16 v[86:87], v10 offset:12800
  s_add_u32 m0, s25, 7168
  s_nop 0
  buffer_load_dwordx4 v16, s[12:15], s27 offen lds
  s_add_u32 s27, s27, 43008
  s_waitcnt lgkmcnt(6)
  v_mfma_f32_32x32x16_bf16 v[48:63], v[96:99], v[164:167], v[48:63]
  ds_read_b64_tr_b16 v[88:89], v9 offset:14336
  ds_read_b64_tr_b16 v[90:91], v9 offset:14848
  s_waitcnt lgkmcnt(6)
  v_mfma_f32_32x32x16_bf16 v[64:79], v[100:103], v[164:167], v[64:79]
  ds_read_b64_tr_b16 v[92:93], v10 offset:14336
  ds_read_b64_tr_b16 v[94:95], v10 offset:14848
  s_waitcnt lgkmcnt(6)
  v_mfma_f32_32x32x16_bf16 v[48:63], v[80:83], v[168:171], v[48:63]
  ds_read_b64_tr_b16 v[96:97], v9 offset:16384
  ds_read_b64_tr_b16 v[98:99], v9 offset:16896
  s_waitcnt lgkmcnt(6)
  v_mfma_f32_32x32x16_bf16 v[64:79], v[84:87], v[168:171], v[64:79]
  ds_read_b64_tr_b16 v[100:101], v10 offset:16384
  ds_read_b64_tr_b16 v[102:103], v10 offset:16896
  s_waitcnt lgkmcnt(6)
  v_mfma_f32_32x32x16_bf16 v[48:63], v[88:91], v[172:175], v[48:63]
  ds_read_b64_tr_b16 v[80:81], v9 offset:18432
  ds_read_b64_tr_b16 v[82:83], v9 offset:18944
  s_waitcnt vmcnt(8)
  s_mov_b64 exec, 1
  ds_add_u32 v13, v12 offset:64
  s_mov_b64 exec, -1
  ds_read_b128 v[224:227], v5 offset:8192
  ds_read_b128 v[228:231], v6 offset:8192
  ds_read_b128 v[232:235], v7 offset:8192
  ds_read_b128 v[236:239], v8 offset:8192
  s_waitcnt lgkmcnt(11)
  v_mfma_f32_32x32x16_bf16 v[64:79], v[92:95], v[172:175], v[64:79]
  ds_read_b64_tr_b16 v[84:85], v10 offset:18432
  ds_read_b64_tr_b16 v[86:87], v10 offset:18944
  s_waitcnt lgkmcnt(11)
  v_mfma_f32_32x32x16_bf16 v[48:63], v[96:99], v[176:179], v[48:63]
  ds_read_b64_tr_b16 v[88:89], v9 offset:20480
  ds_read_b64_tr_b16 v[90:91], v9 offset:20992
  s_waitcnt lgkmcnt(4)
  s_add_u32 m0, s25, 8192
  s_nop 0
  buffer_load_dwordx4 v16, s[12:15], s27 offen lds
  s_add_u32 s27, s27, 43008
  v_mfma_f32_32x32x16_bf16 v[64:79], v[100:103], v[176:179], v[64:79]
  ds_read_b64_tr_b16 v[92:93], v10 offset:20480
  ds_read_b64_tr_b16 v[94:95], v10 offset:20992
  s_add_u32 m0, s25, 9216
  s_nop 0
  buffer_load_dwordx4 v16, s[12:15], s27 offen lds
  s_add_u32 s27, s27, 43008
  v_mfma_f32_32x32x16_bf16 v[48:63], v[80:83], v[180:183], v[48:63]
  ds_read_b64_tr_b16 v[96:97], v9 offset:22528
  ds_read_b64_tr_b16 v[98:99], v9 offset:23040
  s_add_u32 m0, s25, 10240
  s_nop 0
  buffer_load_dwordx4 v16, s[12:15], s27 offen lds
  s_waitcnt lgkmcnt(6)
  v_mfma_f32_32x32x16_bf16 v[64:79], v[84:87], v[180:183], v[64:79]
  ds_read_b64_tr_b16 v[100:101], v10 offset:22528
  ds_read_b64_tr_b16 v[102:103], v10 offset:23040
  s_waitcnt lgkmcnt(6)
  v_mfma_f32_32x32x16_bf16 v[48:63], v[88:91], v[184:187], v[48:63]
  ds_read_b64_tr_b16 v[80:81], v9 offset:24576
  ds_read_b64_tr_b16 v[82:83], v9 offset:25088
  s_waitcnt lgkmcnt(6)
  v_mfma_f32_32x32x16_bf16 v[64:79], v[92:95], v[184:187], v[64:79]
  ds_read_b64_tr_b16 v[84:85], v10 offset:24576
  ds_read_b64_tr_b16 v[86:87], v10 offset:25088
  s_waitcnt lgkmcnt(6)
  v_mfma_f32_32x32x16_bf16 v[48:63], v[96:99], v[188:191], v[48:63]
  ds_read_b64_tr_b16 v[88:89], v9 offset:26624
  ds_read_b64_tr_b16 v[90:91], v9 offset:27136
  s_waitcnt lgkmcnt(6)
  v_mfma_f32_32x32x16_bf16 v[64:79], v[100:103], v[188:191], v[64:79]
  ds_read_b64_tr_b16 v[92:93], v10 offset:26624
  ds_read_b64_tr_b16 v[94:95], v10 offset:27136
  s_waitcnt lgkmcnt(6)
  v_mfma_f32_32x32x16_bf16 v[48:63], v[80:83], v[192:195], v[48:63]
  ds_read_b64_tr_b16 v[96:97], v9 offset:28672
  ds_read_b64_tr_b16 v[98:99], v9 offset:29184
  ds_read_b32 v23, v13 offset:64
  s_waitcnt lgkmcnt(7)
  v_mfma_f32_32x32x16_bf16 v[64:79], v[84:87], v[192:195], v[64:79]
  ds_read_b64_tr_b16 v[100:101], v10 offset:28672
  ds_read_b64_tr_b16 v[102:103], v10 offset:29184
  s_waitcnt lgkmcnt(7)
  v_mfma_f32_32x32x16_bf16 v[48:63], v[88:91], v[196:199], v[48:63]
  ds_read_b64_tr_b16 v[80:81], v9 offset:30720
  ds_read_b64_tr_b16 v[82:83], v9 offset:31232
  s_waitcnt lgkmcnt(7)
  v_mfma_f32_32x32x16_bf16 v[64:79], v[92:95], v[196:199], v[64:79]
  ds_read_b64_tr_b16 v[84:85], v10 offset:30720
  ds_read_b64_tr_b16 v[86:87], v10 offset:31232
  s_waitcnt lgkmcnt(6)
  v_readfirstlane_b32 s65, v23
  s_cmp_ge_u32 s65, 4
  s_cbranch_scc1 Lsx_5
  s_mov_b32 s64, 0
Lsp_4:
  ds_read_b32 v23, v13 offset:64
  s_add_u32 s64, s64, 1
  s_waitcnt lgkmcnt(0)
  v_readfirstlane_b32 s65, v23
  s_cmp_ge_u32 s65, 4
  s_cbranch_scc1 Lsx_5
  s_cmp_lt_u32 s64, 200000
  s_cbranch_scc1 Lsp_4
Lsx_5:
  v_mfma_f32_32x32x16_bf16 v[48:63], v[96:99], v[200:203], v[48:63]
  ds_read_b64_tr_b16 v[88:89], v9 offset:32768
  ds_read_b64_tr_b16 v[90:91], v9 offset:33280
  s_waitcnt lgkmcnt(6)
  v_mfma_f32_32x32x16_bf16 v[64:79], v[100:103], v[200:203], v[64:79]
  ds_read_b64_tr_b16 v[92:93], v10 offset:32768
  ds_read_b64_tr_b16 v[94:95], v10 offset:33280
  s_waitcnt lgkmcnt(6)
  v_mfma_f32_32x32x16_bf16 v[48:63], v[80:83], v[204:207], v[48:63]
  ds_read_b64_tr_b16 v[96:97], v9 offset:34816
  ds_read_b64_tr_b16 v[98:99], v9 offset:35328
  s_waitcnt vmcnt(7)
  ds_read_b128 v[240:243], v5 offset:0
  ds_read_b128 v[244:247], v6 offset:0
  ds_read_b128 v[248:251], v7 offset:0
  ds_read_b128 v[252:255], v8 offset:0
  s_waitcnt lgkmcnt(10)
  v_mfma_f32_32x32x16_bf16 v[64:79], v[84:87], v[204:207], v[64:79]
  ds_read_b64_tr_b16 v[100:101], v10 offset:34816
  ds_read_b64_tr_b16 v[102:103], v10 offset:35328
  s_waitcnt lgkmcnt(10)
  v_mfma_f32_32x32x16_bf16 v[48:63], v[88:91], v[208:211], v[48:63]
  ds_read_b64_tr_b16 v[80:81], v9 offset:36864
  ds_read_b64_tr_b16 v[82:83], v9 offset:37376
  s_waitcnt lgkmcnt(10)
  v_mfma_f32_32x32x16_bf16 v[64:79], v[92:95], v[208:211], v[64:79]
  ds_read_b64_tr_b16 v[84:85], v10 offset:36864
  ds_read_b64_tr_b16 v[86:87], v10 offset:37376
  s_waitcnt lgkmcnt(10)
  v_mfma_f32_32x32x16_bf16 v[48:63], v[96:99], v[212:215], v[48:63]
  ds_read_b64_tr_b16 v[88:89], v9 offset:38912
  ds_read_b64_tr_b16 v[90:91], v9 offset:39424
  s_waitcnt lgkmcnt(6)
  v_mfma_f32_32x32x16_bf16 v[64:79], v[100:103], v[212:215], v[64:79]
  ds_read_b64_tr_b16 v[92:93], v10 offset:38912
  ds_read_b64_tr_b16 v[94:95], v10 offset:39424
  s_waitcnt lgkmcnt(6)
  v_mfma_f32_32x32x16_bf16 v[48:63], v[80:83], v[216:219], v[48:63]
  ds_read_b64_tr_b16 v[96:97], v9 offset:40960
  ds_read_b64_tr_b16 v[98:99], v9 offset:41472
  s_waitcnt lgkmcnt(6)
  v_mfma_f32_32x32x16_bf16 v[64:79], v[84:87], v[216:219], v[64:79]
  ds_read_b64_tr_b16 v[100:101], v10 offset:40960
  ds_read_b64_tr_b16 v[102:103], v10 offset:41472
  s_waitcnt lgkmcnt(6)
  v_mfma_f32_32x32x16_bf16 v[48:63], v[88:91], v[220:223], v[48:63]
  ds_read_b64_tr_b16 v[80:81], v9 offset:43008
  ds_read_b64_tr_b16 v[82:83], v9 offset:43520
  s_waitcnt lgkmcnt(6)
  v_mfma_f32_32x32x16_bf16 v[64:79], v[92:95], v[220:223], v[64:79]
  ds_read_b64_tr_b16 v[84:85], v10 offset:43008
  ds_read_b64_tr_b16 v[86:87], v10 offset:43520
  s_waitcnt lgkmcnt(6)
  v_mfma_f32_32x32x16_bf16 v[48:63], v[96:99], v[224:227], v[48:63]
  ds_read_b64_tr_b16 v[88:89], v9 offset:45056
  ds_read_b64_tr_b16 v[90:91], v9 offset:45568
  s_waitcnt lgkmcnt(6)
  v_mfma_f32_32x32x16_bf16 v[64:79], v[100:103], v[224:227], v[64:79]
  s_branch Lpg_P1
Lh_P1:
  s_branch La_head
Lpg_P1:
  ds_read_b64_tr_b16 v[92:93], v10 offset:45056
  ds_read_b64_tr_b16 v[94:95], v10 offset:45568
  s_waitcnt lgkmcnt(6)
  v_mfma_f32_32x32x16_bf16 v[48:63], v[80:83], v[228:231], v[48:63]
  ds_read_b64_tr_b16 v[96:97], v9 offset:47104
  ds_read_b64_tr_b16 v[98:99], v9 offset:47616
  s_waitcnt lgkmcnt(6)
  v_mfma_f32_32x32x16_bf16 v[64:79], v[84:87], v[228:231], v[64:79]
  ds_read_b64_tr_b16 v[100:101], v10 offset:47104
  ds_read_b64_tr_b16 v[102:103], v10 offset:47616
  s_waitcnt lgkmcnt(6)
  v_mfma_f32_32x32x16_bf16 v[48:63], v[88:91], v[232:235], v[48:63]
  ds_read_b64_tr_b16 v[80:81], v9 offset:49152
  ds_read_b64_tr_b16 v[82:83], v9 offset:49664
  s_waitcnt lgkmcnt(6)
  v_mfma_f32_32x32x16_bf16 v[64:79], v[92:95], v[232:235], v[64:79]
  ds_read_b64_tr_b16 v[84:85], v10 offset:49152
  ds_read_b64_tr_b16 v[86:87], v10 offset:49664
  s_waitcnt lgkmcnt(6)
  v_mfma_f32_32x32x16_bf16 v[48:63], v[96:99], v[236:239], v[48:63]
  ds_read_b64_tr_b16 v[88:89], v9 offset:51200
  ds_read_b64_tr_b16 v[90:91], v9 offset:51712
  s_waitcnt lgkmcnt(6)
  v_mfma_f32_32x32x16_bf16 v[64:79], v[100:103], v[236:239], v[64:79]
  ds_read_b64_tr_b16 v[92:93], v10 offset:51200
  ds_read_b64_tr_b16 v[94:95], v10 offset:51712
  s_waitcnt lgkmcnt(6)
  v_mfma_f32_32x32x16_bf16 v[48:63], v[80:83], v[240:243], v[48:63]
  ds_read_b64_tr_b16 v[96:97], v9 offset:53248
  ds_read_b64_tr_b16 v[98:99], v9 offset:53760
  s_waitcnt lgkmcnt(6)
  v_mfma_f32_32x32x16_bf16 v[64:79], v[84:87], v[240:243], v[64:79]
  ds_read_b64_tr_b16 v[100:101], v10 offset:53248
  ds_read_b64_tr_b16 v[102:103], v10 offset:53760
  s_waitcnt lgkmcnt(6)
  v_mfma_f32_32x32x16_bf16 v[48:63], v[88:91], v[244:247], v[48:63]
  ds_read_b64_tr_b16 v[80:81], v9 offset:55296
  ds_read_b64_tr_b16 v[82:83], v9 offset:55808
  s_waitcnt lgkmcnt(6)
  v_mfma_f32_32x32x16_bf16 v[64:79], v[92:95], v[244:247], v[64:79]
  ds_read_b64_tr_b16 v[84:85], v10 offset:55296
  ds_read_b64_tr_b16 v[86:87], v10 offset:55808
  s_waitcnt lgkmcnt(6)
  v_mfma_f32_32x32x16_bf16 v[48:63], v[96:99], v[248:251], v[48:63]
  s_waitcnt lgkmcnt(4)
  v_mfma_f32_32x32x16_bf16 v[64:79], v[100:103], v[248:251], v[64:79]
  s_waitcnt lgkmcnt(2)
  v_mfma_f32_32x32x16_bf16 v[48:63], v[80:83], v[252:255], v[48:63]
  s_waitcnt lgkmcnt(0)
  v_mfma_f32_32x32x16_bf16 v[64:79], v[84:87], v[252:255], v[64:79]
  s_nop 9
  v_cvt_pk_bf16_f32 v104, v48, v49
  v_cvt_pk_bf16_f32 v105, v50, v51
  v_cvt_pk_bf16_f32 v106, v52, v53
  v_cvt_pk_bf16_f32 v107, v54, v55
  buffer_store_dwordx4 v[104:107], v18, s[20:23], s32 offen offset:0 sc1
  v_cvt_pk_bf16_f32 v108, v56, v57
  v_cvt_pk_bf16_f32 v109, v58, v59
  v_cvt_pk_bf16_f32 v110, v60, v61
  v_cvt_pk_bf16_f32 v111, v62, v63
  buffer_store_dwordx4 v[108:111], v18, s[20:23], s33 offen offset:0 sc1
  v_cvt_pk_bf16_f32 v112, v64, v65
  v_cvt_pk_bf16_f32 v113, v66, v67
  v_cvt_pk_bf16_f32 v114, v68, v69
  v_cvt_pk_bf16_f32 v115, v70, v71
  buffer_store_dwordx4 v[112:115], v18, s[20:23], s32 offen offset:2048 sc1
  v_cvt_pk_bf16_f32 v116, v72, v73
  v_cvt_pk_bf16_f32 v117, v74, v75
  v_cvt_pk_bf16_f32 v118, v76, v77
  v_cvt_pk_bf16_f32 v119, v78, v79
  buffer_store_dwordx4 v[116:119], v18, s[20:23], s33 offen offset:2048 sc1
  s_waitcnt vmcnt(4)
  s_mov_b64 exec, 1
  ds_add_u32 v13, v12 offset:16
  s_mov_b64 exec, -1
  ds_read_b32 v23, v13 offset:16
  s_branch Lkv_done
Lkv_v:
  s_waitcnt lgkmcnt(6)
  v_mfma_f32_32x32x16_bf16 v[48:63], v[144:147], v[80:83], 0
  ds_read_b64_tr_b16 v[96:97], v9 offset:4096
  ds_read_b64_tr_b16 v[98:99], v9 offset:4608
  s_waitcnt lgkmcnt(6)
  v_mfma_f32_32x32x16_bf16 v[64:79], v[144:147], v[84:87], 0
  ds_read_b64_tr_b16 v[100:101], v10 offset:4096
  ds_read_b64_tr_b16 v[102:103], v10 offset:4608
  s_waitcnt lgkmcnt(6)
  v_mfma_f32_32x32x16_bf16 v[48:63], v[148:151], v[88:91], v[48:63]
  ds_read_b64_tr_b16 v[80:81], v9 offset:6144
  ds_read_b64_tr_b16 v[82:83], v9 offset:6656
  s_waitcnt lgkmcnt(6)
  v_mfma_f32_32x32x16_bf16 v[64:79], v[148:151], v[92:95], v[64:79]
  ds_read_b64_tr_b16 v[84:85], v10 offset:6144
  ds_read_b64_tr_b16 v[86:87], v10 offset:6656
  s_waitcnt lgkmcnt(6)
  v_mfma_f32_32x32x16_bf16 v[48:63], v[152:155], v[96:99], v[48:63]
  ds_read_b64_tr_b16 v[88:89], v9 offset:8192
  ds_read_b64_tr_b16 v[90:91], v9 offset:8704
  s_waitcnt vmcnt(10)
  ds_read_b128 v[208:211], v5 offset:4096
  ds_read_b128 v[212:215], v6 offset:4096
  ds_read_b128 v[216:219], v7 offset:4096
  ds_read_b128 v[220:223], v8 offset:4096
  s_waitcnt lgkmcnt(10)
  v_mfma_f32_32x32x16_bf16 v[64:79], v[152:155], v[100:103], v[64:79]
  ds_read_b64_tr_b16 v[92:93], v10 offset:8192
  ds_read_b64_tr_b16 v[94:95], v10 offset:8704
  s_waitcnt lgkmcnt(10)
  v_mfma_f32_32x32x16_bf16 v[48:63], v[156:159], v[80:83], v[48:63]
  ds_read_b64_tr_b16 v[96:97], v9 offset:10240
  ds_read_b64_tr_b16 v[98:99], v9 offset:10752
  s_waitcnt lgkmcnt(4)
  s_add_u32 m0, s25, 4096
  s_nop 0
  buffer_load_dwordx4 v16, s[12:15], s27 offen lds
  s_add_u32 s27, s27, 43008
  v_mfma_f32_32x32x16_bf16 v[64:79], v[156:159], v[84:87], v[64:79]
  ds_read_b64_tr_b16 v[100:101], v10 offset:10240
  ds_read_b64_tr_b16 v[102:103], v10 offset:10752
  s_add_u32 m0, s25, 5120
  s_nop 0
  buffer_load_dwordx4 v16, s[12:15], s27 offen lds
  s_add_u32 s27, s27, 43008
  v_mfma_f32_32x32x16_bf16 v[48:63], v[160:163], v[88:91], v[48:63]
  ds_read_b64_tr_b16 v[80:81], v9 offset:12288
  ds_read_b64_tr_b16 v[82:83], v9 offset:12800
  s_add_u32 m0, s25, 6144
  s_nop 0
  buffer_load_dwordx4 v16, s[12:15], s27 offen lds
  s_add_u32 s27, s27, 43008
  s_waitcnt lgkmcnt(6)
  v_mfma_f32_32x32x16_bf16 v[64:79], v[160:163], v[92:95], v[64:79]
  ds_read_b64_tr_b16 v[84:85], v10 offset:12288
  ds_read_b64_tr_b16 v[86:87], v10 offset:12800
  s_add_u32 m0, s25, 7168
  s_nop 0
  buffer_load_dwordx4 v16, s[12:15], s27 offen lds
  s_add_u32 s27, s27, 43008
  s_waitcnt lgkmcnt(6)
  v_mfma_f32_32x32x16_bf16 v[48:63], v[164:167], v[96:99], v[48:63]
  ds_read_b64_tr_b16 v[88:89], v9 offset:14336
  ds_read_b64_tr_b16 v[90:91], v9 offset:14848
  s_waitcnt lgkmcnt(6)
  v_mfma_f32_32x32x16_bf16 v[64:79], v[164:167], v[100:103], v[64:79]
  ds_read_b64_tr_b16 v[92:93], v10 offset:14336
  ds_read_b64_tr_b16 v[94:95], v10 offset:14848
  s_waitcnt lgkmcnt(6)
  v_mfma_f32_32x32x16_bf16 v[48:63], v[168:171], v[80:83], v[48:63]
  ds_read_b64_tr_b16 v[96:97], v9 offset:16384
  ds_read_b64_tr_b16 v[98:99], v9 offset:16896
  s_waitcnt lgkmcnt(6)
  v_mfma_f32_32x32x16_bf16 v[64:79], v[168:171], v[84:87], v[64:79]
  ds_read_b64_tr_b16 v[100:101], v10 offset:16384
  ds_read_b64_tr_b16 v[102:103], v10 offset:16896
  s_waitcnt lgkmcnt(6)
  v_mfma_f32_32x32x16_bf16 v[48:63], v[172:175], v[88:91], v[48:63]
  ds_read_b64_tr_b16 v[80:81], v9 offset:18432
  ds_read_b64_tr_b16 v[82:83], v9 offset:18944
  s_waitcnt vmcnt(8)
  s_mov_b64 exec, 1
  ds_add_u32 v13, v12 offset:64
  s_mov_b64 exec, -1
  ds_read_b128 v[224:227], v5 offset:8192
  ds_read_b128 v[228:231], v6 offset:8192
  ds_read_b128 v[232:235], v7 offset:8192
  ds_read_b128 v[236:239], v8 offset:8192
  s_waitcnt lgkmcnt(11)
  v_mfma_f32_32x32x16_bf16 v[64:79], v[172:175], v[92:95], v[64:79]
  ds_read_b64_tr_b16 v[84:85], v10 offset:18432
  ds_read_b64_tr_b16 v[86:87], v10 offset:18944
  s_waitcnt lgkmcnt(11)
  v_mfma_f32_32x32x16_bf16 v[48:63], v[176:179], v[96:99], v[48:63]
  ds_read_b64_tr_b16 v[88:89], v9 offset:20480
  ds_read_b64_tr_b16 v[90:91], v9 offset:20992
  s_waitcnt lgkmcnt(4)
  s_add_u32 m0, s25, 8192
  s_nop 0
  buffer_load_dwordx4 v16, s[12:15], s27 offen lds
  s_add_u32 s27, s27, 43008
  v_mfma_f32_32x32x16_bf16 v[64:79], v[176:179], v[100:103], v[64:79]
  ds_read_b64_tr_b16 v[92:93], v10 offset:20480
  ds_read_b64_tr_b16 v[94:95], v10 offset:20992
  s_add_u32 m0, s25, 9216
  s_nop 0
  buffer_load_dwordx4 v16, s[12:15], s27 offen lds
  s_add_u32 s27, s27, 43008
  v_mfma_f32_32x32x16_bf16 v[48:63], v[180:183], v[80:83], v[48:63]
  ds_read_b64_tr_b16 v[96:97], v9 offset:22528
  ds_read_b64_tr_b16 v[98:99], v9 offset:23040
  s_add_u32 m0, s25, 10240
  s_nop 0
  buffer_load_dwordx4 v16, s[12:15], s27 offen lds
  s_waitcnt lgkmcnt(6)
  v_mfma_f32_32x32x16_bf16 v[64:79], v[180:183], v[84:87], v[64:79]
  ds_read_b64_tr_b16 v[100:101], v10 offset:22528
  ds_read_b64_tr_b16 v[102:103], v10 offset:23040
  s_waitcnt lgkmcnt(6)
  v_mfma_f32_32x32x16_bf16 v[48:63], v[184:187], v[88:91], v[48:63]
  ds_read_b64_tr_b16 v[80:81], v9 offset:24576
  ds_read_b64_tr_b16 v[82:83], v9 offset:25088
  s_waitcnt lgkmcnt(6)
  v_mfma_f32_32x32x16_bf16 v[64:79], v[184:187], v[92:95], v[64:79]
  ds_read_b64_tr_b16 v[84:85], v10 offset:24576
  ds_read_b64_tr_b16 v[86:87], v10 offset:25088
  s_waitcnt lgkmcnt(6)
  v_mfma_f32_32x32x16_bf16 v[48:63], v[188:191], v[96:99], v[48:63]
  ds_read_b64_tr_b16 v[88:89], v9 offset:26624
  ds_read_b64_tr_b16 v[90:91], v9 offset:27136
  s_waitcnt lgkmcnt(6)
  v_mfma_f32_32x32x16_bf16 v[64:79], v[188:191], v[100:103], v[64:79]
  ds_read_b64_tr_b16 v[92:93], v10 offset:26624
  ds_read_b64_tr_b16 v[94:95], v10 offset:27136
  s_waitcnt lgkmcnt(6)
  v_mfma_f32_32x32x16_bf16 v[48:63], v[192:195], v[80:83], v[48:63]
  ds_read_b64_tr_b16 v[96:97], v9 offset:28672
  ds_read_b64_tr_b16 v[98:99], v9 offset:29184
  ds_read_b32 v23, v13 offset:64
  s_waitcnt lgkmcnt(7)
  v_mfma_f32_32x32x16_bf16 v[64:79], v[192:195], v[84:87], v[64:79]
  ds_read_b64_tr_b16 v[100:101], v10 offset:28672
  ds_read_b64_tr_b16 v[102:103], v10 offset:29184
  s_waitcnt lgkmcnt(7)
  v_mfma_f32_32x32x16_bf16 v[48:63], v[196:199], v[88:91], v[48:63]
  ds_read_b64_tr_b16 v[80:81], v9 offset:30720
  ds_read_b64_tr_b16 v[82:83], v9 offset:31232
  s_waitcnt lgkmcnt(7)
  v_mfma_f32_32x32x16_bf16 v[64:79], v[196:199], v[92:95], v[64:79]
  ds_read_b64_tr_b16 v[84:85], v10 offset:30720
  ds_read_b64_tr_b16 v[86:87], v10 offset:31232
  s_waitcnt lgkmcnt(6)
  v_readfirstlane_b32 s65, v23
  s_cmp_ge_u32 s65, 4
  s_cbranch_scc1 Lsx_8
  s_mov_b32 s64, 0
Lsp_7:
  ds_read_b32 v23, v13 offset:64
  s_add_u32 s64, s64, 1
  s_waitcnt lgkmcnt(0)
  v_readfirstlane_b32 s65, v23
  s_cmp_ge_u32 s65, 4
  s_cbranch_scc1 Lsx_8
  s_cmp_lt_u32 s64, 200000
  s_cbranch_scc1 Lsp_7
Lsx_8:
  v_mfma_f32_32x32x16_bf16 v[48:63], v[200:203], v[96:99], v[48:63]
  ds_read_b64_tr_b16 v[88:89], v9 offset:32768
  ds_read_b64_tr_b16 v[90:91], v9 offset:33280
  s_waitcnt lgkmcnt(6)
  v_mfma_f32_32x32x16_bf16 v[64:79], v[200:203], v[100:103], v[64:79]
  ds_read_b64_tr_b16 v[92:93], v10 offset:32768
  ds_read_b64_tr_b16 v[94:95], v10 offset:33280
  s_waitcnt lgkmcnt(6)
  v_mfma_f32_32x32x16_bf16 v[48:63], v[204:207], v[80:83], v[48:63]
  ds_read_b64_tr_b16 v[96:97], v9 offset:34816
  ds_read_b64_tr_b16 v[98:99], v9 offset:35328
  s_waitcnt vmcnt(7)
  ds_read_b128 v[240:243], v5 offset:0
  ds_read_b128 v[244:247], v6 offset:0
  ds_read_b128 v[248:251], v7 offset:0
  ds_read_b128 v[252:255], v8 offset:0
  s_waitcnt lgkmcnt(10)
  v_mfma_f32_32x32x16_bf16 v[64:79], v[204:207], v[84:87], v[64:79]
  ds_read_b64_tr_b16 v[100:101], v10 offset:34816
  ds_read_b64_tr_b16 v[102:103], v10 offset:35328
  s_waitcnt lgkmcnt(10)
  v_mfma_f32_32x32x16_bf16 v[48:63], v[208:211], v[88:91], v[48:63]
  ds_read_b64_tr_b16 v[80:81], v9 offset:36864
  ds_read_b64_tr_b16 v[82:83], v9 offset:37376
  s_waitcnt lgkmcnt(10)
  v_mfma_f32_32x32x16_bf16 v[64:79], v[208:211], v[92:95], v[64:79]
  ds_read_b64_tr_b16 v[84:85], v10 offset:36864
  ds_read_b64_tr_b16 v[86:87], v10 offset:37376
  s_waitcnt lgkmcnt(10)
  v_mfma_f32_32x32x16_bf16 v[48:63], v[212:215], v[96:99], v[48:63]
  ds_read_b64_tr_b16 v[88:89], v9 offset:38912
  ds_read_b64_tr_b16 v[90:91], v9 offset:39424
  s_waitcnt lgkmcnt(6)
  v_mfma_f32_32x32x16_bf16 v[64:79], v[212:215], v[100:103], v[64:79]
  ds_read_b64_tr_b16 v[92:93], v10 offset:38912
  ds_read_b64_tr_b16 v[94:95], v10 offset:39424
  s_waitcnt lgkmcnt(6)
  v_mfma_f32_32x32x16_bf16 v[48:63], v[216:219], v[80:83], v[48:63]
  ds_read_b64_tr_b16 v[96:97], v9 offset:40960
  ds_read_b64_tr_b16 v[98:99], v9 offset:41472
  s_waitcnt lgkmcnt(6)
  v_mfma_f32_32x32x16_bf16 v[64:79], v[216:219], v[84:87], v[64:79]
  ds_read_b64_tr_b16 v[100:101], v10 offset:40960
  ds_read_b64_tr_b16 v[102:103], v10 offset:41472
  s_waitcnt lgkmcnt(6)
  v_mfma_f32_32x32x16_bf16 v[48:63], v[220:223], v[88:91], v[48:63]
  ds_read_b64_tr_b16 v[80:81], v9 offset:43008
  ds_read_b64_tr_b16 v[82:83], v9 offset:43520
  s_waitcnt lgkmcnt(6)
  v_mfma_f32_32x32x16_bf16 v[64:79], v[220:223], v[92:95], v[64:79]
  ds_read_b64_tr_b16 v[84:85], v10 offset:43008
  ds_read_b64_tr_b16 v[86:87], v10 offset:43520
  s_waitcnt lgkmcnt(6)
  v_mfma_f32_32x32x16_bf16 v[48:63], v[224:227], v[96:99], v[48:63]
  ds_read_b64_tr_b16 v[88:89], v9 offset:45056
  ds_read_b64_tr_b16 v[90:91], v9 offset:45568
  s_waitcnt lgkmcnt(6)
  v_mfma_f32_32x32x16_bf16 v[64:79], v[224:227], v[100:103], v[64:79]
  ds_read_b64_tr_b16 v[92:93], v10 offset:45056
  ds_read_b64_tr_b16 v[94:95], v10 offset:45568
  s_waitcnt lgkmcnt(6)
  v_mfma_f32_32x32x16_bf16 v[48:63], v[228:231], v[80:83], v[48:63]
  ds_read_b64_tr_b16 v[96:97], v9 offset:47104
  ds_read_b64_tr_b16 v[98:99], v9 offset:47616
  s_waitcnt lgkmcnt(6)
  v_mfma_f32_32x32x16_bf16 v[64:79], v[228:231], v[84:87], v[64:79]
  ds_read_b64_tr_b16 v[100:101], v10 offset:47104
  ds_read_b64_tr_b16 v[102:103], v10 offset:47616
  s_waitcnt lgkmcnt(6)
  v_mfma_f32_32x32x16_bf16 v[48:63], v[232:235], v[88:91], v[48:63]
  ds_read_b64_tr_b16 v[80:81], v9 offset:49152
  ds_read_b64_tr_b16 v[82:83], v9 offset:49664
  s_waitcnt lgkmcnt(6)
  v_mfma_f32_32x32x16_bf16 v[64:79], v[232:235], v[92:95], v[64:79]
  ds_read_b64_tr_b16 v[84:85], v10 offset:49152
  ds_read_b64_tr_b16 v[86:87], v10 offset:49664
  s_waitcnt lgkmcnt(6)
  v_mfma_f32_32x32x16_bf16 v[48:63], v[236:239], v[96:99], v[48:63]
  ds_read_b64_tr_b16 v[88:89], v9 offset:51200
  ds_read_b64_tr_b16 v[90:91], v9 offset:51712
  s_waitcnt lgkmcnt(6)
  v_mfma_f32_32x32x16_bf16 v[64:79], v[236:239], v[100:103], v[64:79]
  ds_read_b64_tr_b16 v[92:93], v10 offset:51200
  ds_read_b64_tr_b16 v[94:95], v10 offset:51712
  s_waitcnt lgkmcnt(6)
  v_mfma_f32_32x32x16_bf16 v[48:63], v[240:243], v[80:83], v[48:63]
  ds_read_b64_tr_b16 v[96:97], v9 offset:53248
  ds_read_b64_tr_b16 v[98:99], v9 offset:53760
  s_waitcnt lgkmcnt(6)
  v_mfma_f32_32x32x16_bf16 v[64:79], v[240:243], v[84:87], v[64:79]
  ds_read_b64_tr_b16 v[100:101], v10 offset:53248
  ds_read_b64_tr_b16 v[102:103], v10 offset:53760
  s_waitcnt lgkmcnt(6)
  v_mfma_f32_32x32x16_bf16 v[48:63], v[244:247], v[88:91], v[48:63]
  ds_read_b64_tr_b16 v[80:81], v9 offset:55296
  ds_read_b64_tr_b16 v[82:83], v9 offset:55808
  s_waitcnt lgkmcnt(6)
  v_mfma_f32_32x32x16_bf16 v[64:79], v[244:247], v[92:95], v[64:79]
  ds_read_b64_tr_b16 v[84:85], v10 offset:55296
  ds_read_b64_tr_b16 v[86:87], v10 offset:55808
  s_waitcnt lgkmcnt(6)
  v_mfma_f32_32x32x16_bf16 v[48:63], v[248:251], v[96:99], v[48:63]
  s_waitcnt lgkmcnt(4)
  v_mfma_f32_32x32x16_bf16 v[64:79], v[248:251], v[100:103], v[64:79]
  s_waitcnt lgkmcnt(2)
  v_mfma_f32_32x32x16_bf16 v[48:63], v[252:255], v[80:83], v[48:63]
  s_waitcnt lgkmcnt(0)
  v_mfma_f32_32x32x16_bf16 v[64:79], v[252:255], v[84:87], v[64:79]
  s_nop 9
  v_cvt_pk_bf16_f32 v104, v48, v49
  v_cvt_pk_bf16_f32 v105, v50, v51
  v_cvt_pk_bf16_f32 v106, v52, v53
  v_cvt_pk_bf16_f32 v107, v54, v55
  buffer_store_dwordx4 v[104:107], v19, s[20:23], s32 offen offset:0 sc1
  v_cvt_pk_bf16_f32 v108, v56, v57
  v_cvt_pk_bf16_f32 v109, v58, v59
  v_cvt_pk_bf16_f32 v110, v60, v61
  v_cvt_pk_bf16_f32 v111, v62, v63
  buffer_store_dwordx4 v[108:111], v19, s[20:23], s33 offen offset:0 sc1
  v_cvt_pk_bf16_f32 v112, v64, v65
  v_cvt_pk_bf16_f32 v113, v66, v67
  v_cvt_pk_bf16_f32 v114, v68, v69
  v_cvt_pk_bf16_f32 v115, v70, v71
  buffer_store_dwordx4 v[112:115], v19, s[20:23], s32 offen offset:512 sc1
  v_cvt_pk_bf16_f32 v116, v72, v73
  v_cvt_pk_bf16_f32 v117, v74, v75
  v_cvt_pk_bf16_f32 v118, v76, v77
  v_cvt_pk_bf16_f32 v119, v78, v79
  buffer_store_dwordx4 v[116:119], v19, s[20:23], s33 offen offset:512 sc1
  s_waitcnt vmcnt(4)
  s_mov_b64 exec, 1
  ds_add_u32 v13, v12 offset:16
  s_mov_b64 exec, -1
  ds_read_b32 v23, v13 offset:16
Lkv_done:
  s_waitcnt lgkmcnt(0)
  v_readfirstlane_b32 s65, v23
  s_cmp_ge_u32 s65, 4
  s_cbranch_scc1 Lsx_11
  s_mov_b32 s64, 0
Lsp_10:
  ds_read_b32 v23, v13 offset:16
  s_add_u32 s64, s64, 1
  s_waitcnt lgkmcnt(0)
  v_readfirstlane_b32 s65, v23
  s_cmp_ge_u32 s65, 4
  s_cbranch_scc1 Lsx_11
  s_cmp_lt_u32 s64, 200000
  s_cbranch_scc1 Lsp_10
Lsx_11:
  ds_read_b64_tr_b16 v[80:81], v11 offset:0
  ds_read_b64_tr_b16 v[82:83], v11 offset:256
  ds_read_b64_tr_b16 v[84:85], v11 offset:1024
  ds_read_b64_tr_b16 v[86:87], v11 offset:1280
  ds_read_b64_tr_b16 v[88:89], v11 offset:2048
  ds_read_b64_tr_b16 v[90:91], v11 offset:2304
  ds_read_b64_tr_b16 v[92:93], v11 offset:3072
  ds_read_b64_tr_b16 v[94:95], v11 offset:3328
  ds_read_b64_tr_b16 v[96:97], v11 offset:4096
  ds_read_b64_tr_b16 v[98:99], v11 offset:4352
  s_waitcnt lgkmcnt(8)
  v_mfma_f32_32x32x16_bf16 v[32:47], v[80:83], v[144:147], 0
  ds_read_b64_tr_b16 v[100:101], v11 offset:5120
  ds_read_b64_tr_b16 v[102:103], v11 offset:5376
  v_mov_b32 v64, 0
  v_mov_b32 v65, 0
  s_waitcnt lgkmcnt(8)
  v_mfma_f32_32x32x16_bf16 v[32:47], v[84:87], v[148:151], v[32:47]
  ds_read_b64_tr_b16 v[80:81], v11 offset:6144
  ds_read_b64_tr_b16 v[82:83], v11 offset:6400
  v_mov_b32 v66, 0
  v_mov_b32 v67, 0
  s_waitcnt lgkmcnt(8)
  v_mfma_f32_32x32x16_bf16 v[32:47], v[88:91], v[152:155], v[32:47]
  ds_read_b64_tr_b16 v[84:85], v11 offset:12288
  ds_read_b64_tr_b16 v[86:87], v11 offset:12544
  v_mov_b32 v68, 0
  v_mov_b32 v69, 0
  s_waitcnt lgkmcnt(8)
  v_mfma_f32_32x32x16_bf16 v[32:47], v[92:95], v[156:159], v[32:47]
  ds_read_b64_tr_b16 v[88:89], v11 offset:13312
  ds_read_b64_tr_b16 v[90:91], v11 offset:13568
  v_mov_b32 v70, 0
  v_mov_b32 v71, 0
  s_waitcnt lgkmcnt(8)
  v_mfma_f32_32x32x16_bf16 v[32:47], v[96:99], v[160:163], v[32:47]
  ds_read_b64_tr_b16 v[92:93], v11 offset:14336
  ds_read_b64_tr_b16 v[94:95], v11 offset:14592
  v_mov_b32 v72, 0
  v_mov_b32 v73, 0
  s_waitcnt lgkmcnt(8)
  v_mfma_f32_32x32x16_bf16 v[32:47], v[100:103], v[164:167], v[32:47]
  ds_read_b64_tr_b16 v[96:97], v11 offset:15360
  ds_read_b64_tr_b16 v[98:99], v11 offset:15616
  v_mov_b32 v74, 0
  v_mov_b32 v75, 0
  s_waitcnt lgkmcnt(8)
  v_mfma_f32_32x32x16_bf16 v[32:47], v[80:83], v[168:171], v[32:47]
  ds_read_b64_tr_b16 v[100:101], v11 offset:16384
  ds_read_b64_tr_b16 v[102:103], v11 offset:16640
  v_mov_b32 v76, 0
  v_mov_b32 v77, 0
  s_waitcnt lgkmcnt(8)
  v_mfma_f32_32x32x16_bf16 v[32:47], v[84:87], v[172:175], v[32:47]
  ds_read_b64_tr_b16 v[80:81], v11 offset:17408
  ds_read_b64_tr_b16 v[82:83], v11 offset:17664
  v_mov_b32 v78, 0
  v_mov_b32 v79, 0
  s_waitcnt lgkmcnt(8)
  v_mfma_f32_32x32x16_bf16 v[32:47], v[88:91], v[176:179], v[32:47]
  ds_read_b64_tr_b16 v[84:85], v11 offset:18432
  ds_read_b64_tr_b16 v[86:87], v11 offset:18688
  v_mov_b32 v104, 0
  v_mov_b32 v105, 0
  s_waitcnt lgkmcnt(8)
  v_mfma_f32_32x32x16_bf16 v[32:47], v[92:95], v[180:183], v[32:47]
  ds_read_b64_tr_b16 v[88:89], v11 offset:24576
  ds_read_b64_tr_b16 v[90:91], v11 offset:24832
  v_mov_b32 v106, 0
  v_mov_b32 v107, 0
  s_waitcnt lgkmcnt(8)
  v_mfma_f32_32x32x16_bf16 v[32:47], v[96:99], v[184:187], v[32:47]
  ds_read_b64_tr_b16 v[92:93], v11 offset:25600
  ds_read_b64_tr_b16 v[94:95], v11 offset:25856
  v_mov_b32 v108, 0
  v_mov_b32 v109, 0
  s_waitcnt lgkmcnt(8)
  v_mfma_f32_32x32x16_bf16 v[32:47], v[100:103], v[188:191], v[32:47]
  ds_read_b64_tr_b16 v[96:97], v11 offset:26624
  ds_read_b64_tr_b16 v[98:99], v11 offset:26880
  v_mov_b32 v110, 0
  v_mov_b32 v111, 0
  s_waitcnt lgkmcnt(8)
  v_mfma_f32_32x32x16_bf16 v[32:47], v[80:83], v[192:195], v[32:47]
  ds_read_b64_tr_b16 v[100:101], v11 offset:27648
  ds_read_b64_tr_b16 v[102:103], v11 offset:27904
  v_mov_b32 v112, 0
  v_mov_b32 v113, 0
  s_waitcnt lgkmcnt(8)
  v_mfma_f32_32x32x16_bf16 v[32:47], v[84:87], v[196:199], v[32:47]
  ds_read_b64_tr_b16 v[80:81], v11 offset:28672
  ds_read_b64_tr_b16 v[82:83], v11 offset:28928
  v_mov_b32 v114, 0
  v_mov_b32 v115, 0
  s_waitcnt lgkmcnt(8)
  v_mfma_f32_32x32x16_bf16 v[32:47], v[88:91], v[200:203], v[32:47]
  ds_read_b64_tr_b16 v[84:85], v11 offset:29696
  ds_read_b64_tr_b16 v[86:87], v11 offset:29952
  v_mov_b32 v116, 0
  v_mov_b32 v117, 0
  s_waitcnt lgkmcnt(8)
  v_mfma_f32_32x32x16_bf16 v[32:47], v[92:95], v[204:207], v[32:47]
  ds_read_b64_tr_b16 v[88:89], v11 offset:30720
  ds_read_b64_tr_b16 v[90:91], v11 offset:30976
  v_mov_b32 v118, 0
  v_mov_b32 v119, 0
  s_waitcnt lgkmcnt(8)
  v_mfma_f32_32x32x16_bf16 v[32:47], v[96:99], v[208:211], v[32:47]
  ds_read_b64_tr_b16 v[92:93], v11 offset:36864
  ds_read_b64_tr_b16 v[94:95], v11 offset:37120
  v_mov_b32 v120, 0
  v_mov_b32 v121, 0
  s_waitcnt lgkmcnt(8)
  v_mfma_f32_32x32x16_bf16 v[32:47], v[100:103], v[212:215], v[32:47]
  ds_read_b64_tr_b16 v[96:97], v11 offset:37888
  ds_read_b64_tr_b16 v[98:99], v11 offset:38144
  v_mov_b32 v122, 0
  v_mov_b32 v123, 0
  s_waitcnt lgkmcnt(8)
  v_mfma_f32_32x32x16_bf16 v[32:47], v[80:83], v[216:219], v[32:47]
  ds_read_b64_tr_b16 v[100:101], v11 offset:38912
  ds_read_b64_tr_b16 v[102:103], v11 offset:39168
  v_mov_b32 v124, 0
  v_mov_b32 v125, 0
  s_waitcnt lgkmcnt(8)
  v_mfma_f32_32x32x16_bf16 v[32:47], v[84:87], v[220:223], v[32:47]
  ds_read_b64_tr_b16 v[80:81], v11 offset:39936
  ds_read_b64_tr_b16 v[82:83], v11 offset:40192
  v_mov_b32 v126, 0
  v_mov_b32 v127, 0
  s_waitcnt lgkmcnt(8)
  v_mfma_f32_32x32x16_bf16 v[32:47], v[88:91], v[224:227], v[32:47]
  ds_read_b64_tr_b16 v[84:85], v11 offset:40960
  ds_read_b64_tr_b16 v[86:87], v11 offset:41216
  v_mov_b32 v184, 0
  v_mov_b32 v185, 0
  s_waitcnt vmcnt(0)
  s_mov_b64 exec, 1
  buffer_store_dword v21, v20, s[16:19], s34 offen sc1
  s_mov_b64 exec, -1
  s_waitcnt lgkmcnt(8)
  v_mfma_f32_32x32x16_bf16 v[32:47], v[92:95], v[228:231], v[32:47]
  ds_read_b64_tr_b16 v[88:89], v11 offset:41984
  ds_read_b64_tr_b16 v[90:91], v11 offset:42240
  v_mov_b32 v186, 0
  v_mov_b32 v187, 0
  s_waitcnt lgkmcnt(8)
  v_mfma_f32_32x32x16_bf16 v[32:47], v[96:99], v[232:235], v[32:47]
  ds_read_b64_tr_b16 v[92:93], v11 offset:43008
  ds_read_b64_tr_b16 v[94:95], v11 offset:43264
  v_mov_b32 v188, 0
  v_mov_b32 v189, 0
  s_waitcnt lgkmcnt(8)
  v_mfma_f32_32x32x16_bf16 v[32:47], v[100:103], v[236:239], v[32:47]
  v_mov_b32 v190, 0
  v_mov_b32 v191, 0
  s_waitcnt lgkmcnt(6)
  v_mfma_f32_32x32x16_bf16 v[32:47], v[80:83], v[240:243], v[32:47]
  s_waitcnt lgkmcnt(4)
  v_mfma_f32_32x32x16_bf16 v[32:47], v[84:87], v[244:247], v[32:47]
  s_waitcnt lgkmcnt(2)
  v_mfma_f32_32x32x16_bf16 v[32:47], v[88:91], v[248:251], v[32:47]
  s_waitcnt lgkmcnt(0)
  v_mfma_f32_32x32x16_bf16 v[32:47], v[92:95], v[252:255], v[32:47]
  s_nop 11
  v_mul_f32 v32, v27, v32
  v_mul_f32 v33, v27, v33
  v_mul_f32 v34, v27, v34
  v_mul_f32 v35, v27, v35
  v_mul_f32 v36, v29, v36
  v_mul_f32 v37, v29, v37
  v_mul_f32 v38, v29, v38
  v_mul_f32 v39, v29, v39
  v_mul_f32 v40, v29, v40
  v_mul_f32 v41, v29, v41
  v_mul_f32 v42, v29, v42
  v_mul_f32 v43, v29, v43
  v_mul_f32 v44, v28, v44
  v_mul_f32 v45, v28, v45
  v_mul_f32 v46, v28, v46
  v_mul_f32 v47, v28, v47
  v_cvt_pk_bf16_f32 v56, v32, v33
  v_cvt_pk_bf16_f32 v57, v34, v35
  v_cvt_pk_bf16_f32 v58, v36, v37
  v_cvt_pk_bf16_f32 v59, v38, v39
  v_cvt_pk_bf16_f32 v60, v40, v41
  v_cvt_pk_bf16_f32 v61, v42, v43
  v_cvt_pk_bf16_f32 v62, v44, v45
  v_cvt_pk_bf16_f32 v63, v46, v47
  ds_write_b128 v3, v[56:59]
  ds_write_b128 v3, v[60:63] offset:1024
  s_mov_b64 exec, 1
  ds_add_u32 v13, v12 offset:32
  s_mov_b64 exec, -1
  v_mov_b32 v80, 0
  v_mov_b32 v81, 0
  v_mov_b32 v82, 0
  v_mov_b32 v83, 0
  v_mov_b32 v84, 0
  v_mov_b32 v85, 0
  v_mov_b32 v86, 0
  v_mov_b32 v87, 0
  v_mov_b32 v88, 0
  v_mov_b32 v89, 0
  v_mov_b32 v90, 0
  v_mov_b32 v91, 0
  v_mov_b32 v92, 0
  v_mov_b32 v93, 0
  v_mov_b32 v94, 0
  v_mov_b32 v95, 0
  v_mov_b32 v96, 0
  v_mov_b32 v97, 0
  v_mov_b32 v98, 0
  v_mov_b32 v99, 0
  v_mov_b32 v100, 0
  v_mov_b32 v101, 0
  v_mov_b32 v102, 0
  v_mov_b32 v103, 0
  v_mov_b32 v252, 0
  v_mov_b32 v253, 0
  v_mov_b32 v254, 0
  v_mov_b32 v255, 0
  v_mov_b32 v9, 0xdddddddd
  ds_read_b32 v23, v13 offset:32
  s_waitcnt lgkmcnt(0)
  v_readfirstlane_b32 s65, v23
  s_cmp_ge_u32 s65, 4
  s_cbranch_scc1 Lsx_14
  s_mov_b32 s64, 0
Lsp_13:
  ds_read_b32 v23, v13 offset:32
  s_add_u32 s64, s64, 1
  s_waitcnt lgkmcnt(0)
  v_readfirstlane_b32 s65, v23
  s_cmp_ge_u32 s65, 4
  s_cbranch_scc1 Lsx_14
  s_cmp_lt_u32 s64, 200000
  s_cbranch_scc1 Lsp_13
Lsx_14:
  s_add_u32 s63, s3, 1
  s_and_b32 s63, s63, 3
  s_mul_i32 s64, s63, 12288
  s_add_u32 s64, s64, 57344
  v_add_u32 v23, s64, v18
  ds_read_b128 v[32:35], v23
  ds_read_b128 v[36:39], v23 offset:1024
  s_mul_i32 s63, s63, 12288
  s_add_u32 s63, s63, 114688
  v_add_u32 v5, s63, v18
  s_add_u32 s63, s3, 2
  s_and_b32 s63, s63, 3
  s_mul_i32 s64, s63, 12288
  s_add_u32 s64, s64, 57344
  v_add_u32 v23, s64, v18
  ds_read_b128 v[40:43], v23
  ds_read_b128 v[44:47], v23 offset:1024
  s_mul_i32 s63, s63, 12288
  s_add_u32 s63, s63, 118784
  v_add_u32 v6, s63, v18
  s_add_u32 s63, s3, 3
  s_and_b32 s63, s63, 3
  s_mul_i32 s64, s63, 12288
  s_add_u32 s64, s64, 57344
  v_add_u32 v23, s64, v18
  ds_read_b128 v[48:51], v23
  ds_read_b128 v[52:55], v23 offset:1024
  s_mul_i32 s63, s63, 12288
  s_add_u32 s63, s63, 122880
  v_add_u32 v7, s63, v18
  s_mov_b64 exec, 1
  ds_add_u32 v13, v12 offset:208
  s_mov_b64 exec, -1
  s_mul_i32 s63, s3, 12288
  s_add_u32 s63, s63, 114688
  v_add_u32 v8, s63, v18
  s_lshl_b32 s63, s68, 4
  s_add_u32 s63, s63, s4
  s_lshl_b32 s63, s63, 11
  s_add_u32 s31, s63, 5242880
  s_mov_b32 s29, 0
  s_mov_b32 s64, 0
  buffer_load_dword v31, v22, s[16:19], 0 offen sc1
  s_branch Lbx0
Lgo_l:
  buffer_load_dword v31, v22, s[16:19], 0 offen sc1
Lgo_e:
Lbx0_r:
  s_add_u32 s64, s64, 1
  s_waitcnt vmcnt(0)
Lgo_c:
  v_cmp_eq_u32 vcc, s62, v31
  s_and_b32 s35, vcc_lo, vcc_hi
  s_lshr_b32 s63, s35, 16
  s_and_b32 s35, s35, s63
  s_cmp_eq_u32 s35, 0xffff
  s_cselect_b32 s35, -1, s35
  s_bcnt1_i32_b32 s63, s35
  s_cmp_ge_u32 s63, 5
  s_cbranch_scc1 Lgo_x
  s_cmp_lt_u32 s64, 200000
  s_cbranch_scc1 Lgo_l
  s_mov_b32 s35, -1
Lgo_x:
  s_and_b32 s37, s36, s35
  s_ff1_i32_b32 s37, s37
  s_bitset0_b32 s36, s37
  s_lshl2_add_u32 s37, s37, s3
  s_mul_i32 s28, s37, 59136
  s_add_u32 s30, s28, 15232
  buffer_load_dwordx4 v[192:195], v24, s[20:23], s28 offen offset:0 sc1
  buffer_load_dwordx4 v[196:199], v24, s[20:23], s28 offen offset:1024 sc1
  buffer_load_dwordx4 v[200:203], v30, s[20:23], s28 offen sc1
  buffer_load_dwordx4 v[204:207], v30, s[20:23], s30 offen sc1
  s_and_b32 s37, s36, s35
  s_ff1_i32_b32 s37, s37
  s_bitset0_b32 s36, s37
  s_lshl2_add_u32 s37, s37, s3
  s_mul_i32 s28, s37, 59136
  s_add_u32 s30, s28, 15232
  buffer_load_dwordx4 v[208:211], v24, s[20:23], s28 offen offset:0 sc1
  buffer_load_dwordx4 v[212:215], v24, s[20:23], s28 offen offset:1024 sc1
  buffer_load_dwordx4 v[216:219], v30, s[20:23], s28 offen sc1
  buffer_load_dwordx4 v[220:223], v30, s[20:23], s30 offen sc1
  s_and_b32 s37, s36, s35
  s_ff1_i32_b32 s37, s37
  s_bitset0_b32 s36, s37
  s_lshl2_add_u32 s37, s37, s3
  s_mul_i32 s28, s37, 59136
  s_add_u32 s30, s28, 15232
  s_branch Lbx1
Lbx1_r:
  s_waitcnt vmcnt(6) lgkmcnt(0)
  v_mfma_f32_32x32x16_bf16 v[128:143], v[192:195], v[32:35], 0
  v_mfma_f32_32x32x16_bf16 v[128:143], v[196:199], v[36:39], v[128:143]
  s_setprio 1
  s_nop 10
  v_exp_f32 v128, v128
  v_exp_f32 v129, v129
  v_mfma_f32_32x32x16_bf16 v[144:159], v[192:195], v[40:43], 0
  buffer_load_dwordx4 v[224:227], v24, s[20:23], s28 offen offset:0 sc1
  s_and_b32 s37, s36, s35
  s_cbranch_scc0 Lslow4
Lsr4:
  v_exp_f32 v130, v130
  v_exp_f32 v131, v131
  v_exp_f32 v132, v132
  v_exp_f32 v133, v133
  v_mfma_f32_32x32x16_bf16 v[144:159], v[196:199], v[44:47], v[144:159]
  buffer_load_dwordx4 v[228:231], v24, s[20:23], s28 offen offset:1024 sc1
  s_ff1_i32_b32 s37, s37
  s_bitset0_b32 s36, s37
  v_exp_f32 v134, v134
  v_exp_f32 v135, v135
  v_exp_f32 v136, v136
  v_exp_f32 v137, v137
  v_smfmac_f32_32x32x32_bf16 v[112:127], v[252:255], v[184:191], v9
  buffer_load_dwordx4 v[232:235], v30, s[20:23], s28 offen sc1
  buffer_load_dword v31, v22, s[16:19], 0 offen sc1
  s_lshl2_add_u32 s37, s37, s3
  v_exp_f32 v138, v138
  v_exp_f32 v139, v139
  v_exp_f32 v140, v140
  v_exp_f32 v141, v141
  s_waitcnt vmcnt(9)
  v_smfmac_f32_32x32x32_bf16 v[64:79], v[200:203], v[128:135], v9
  buffer_load_dwordx4 v[236:239], v30, s[20:23], s30 offen sc1
  s_mul_i32 s28, s37, 59136
  v_exp_f32 v142, v142
  v_exp_f32 v143, v143
  v_exp_f32 v144, v144
  v_exp_f32 v145, v145
  v_mfma_f32_32x32x16_bf16 v[160:175], v[192:195], v[48:51], 0
  s_add_u32 s30, s28, 15232
  v_exp_f32 v146, v146
  v_exp_f32 v147, v147
  v_exp_f32 v148, v148
  v_exp_f32 v149, v149
  v_mfma_f32_32x32x16_bf16 v[160:175], v[196:199], v[52:55], v[160:175]
  v_exp_f32 v150, v150
  v_exp_f32 v151, v151
  v_exp_f32 v152, v152
  v_exp_f32 v153, v153
  s_waitcnt vmcnt(9)
  v_smfmac_f32_32x32x32_bf16 v[64:79], v[204:207], v[136:143], v9
  buffer_load_dwordx4 v[240:243], v24, s[20:23], s28 offen offset:0 sc1
  v_exp_f32 v154, v154
  v_exp_f32 v155, v155
  v_exp_f32 v156, v156
  v_exp_f32 v157, v157
  v_smfmac_f32_32x32x32_bf16 v[80:95], v[200:203], v[144:151], v9
  buffer_load_dwordx4 v[244:247], v24, s[20:23], s28 offen offset:1024 sc1
  v_exp_f32 v158, v158
  v_exp_f32 v159, v159
  v_exp_f32 v160, v160
  v_exp_f32 v161, v161
  v_mfma_f32_32x32x16_bf16 v[176:191], v[192:195], v[56:59], 0
  v_exp_f32 v162, v162
  v_exp_f32 v163, v163
  v_exp_f32 v164, v164
  v_exp_f32 v165, v165
  v_mfma_f32_32x32x16_bf16 v[176:191], v[196:199], v[60:63], v[176:191]
  v_exp_f32 v166, v166
  v_exp_f32 v167, v167
  v_exp_f32 v168, v168
  v_exp_f32 v169, v169
  v_smfmac_f32_32x32x32_bf16 v[80:95], v[204:207], v[152:159], v9
  buffer_load_dwordx4 v[248:251], v30, s[20:23], s28 offen sc1
  v_exp_f32 v170, v170
  v_exp_f32 v171, v171
  v_exp_f32 v172, v172
  v_exp_f32 v173, v173
  v_smfmac_f32_32x32x32_bf16 v[96:111], v[200:203], v[160:167], v9
  buffer_load_dwordx4 v[252:255], v30, s[20:23], s30 offen sc1
  s_waitcnt vmcnt(10)
  v_exp_f32 v174, v174
  v_exp_f32 v175, v175
  v_exp_f32 v176, v176
  v_exp_f32 v177, v177
  v_mfma_f32_32x32x16_bf16 v[128:143], v[208:211], v[32:35], 0
  v_exp_f32 v178, v178
  v_exp_f32 v179, v179
  v_exp_f32 v180, v180
  v_exp_f32 v181, v181
  v_mfma_f32_32x32x16_bf16 v[128:143], v[212:215], v[36:39], v[128:143]
  v_exp_f32 v182, v182
  v_exp_f32 v183, v183
  v_exp_f32 v184, v184
  v_exp_f32 v185, v185
  v_smfmac_f32_32x32x32_bf16 v[96:111], v[204:207], v[168:175], v9
  v_exp_f32 v186, v186
  v_exp_f32 v187, v187
  v_exp_f32 v188, v188
  v_exp_f32 v189, v189
  v_smfmac_f32_32x32x32_bf16 v[112:127], v[200:203], v[176:183], v9
  v_exp_f32 v190, v190
  v_exp_f32 v191, v191
  s_branch Latt_1
Lb1e:
Latt:
  v_exp_f32 v128, v128
  v_exp_f32 v129, v129
  v_mfma_f32_32x32x16_bf16 v[144:159], v[240:243], v[40:43], 0
  s_and_b32 s37, s36, s35
  s_cbranch_scc0 Lslow3
Lsr3:
  v_exp_f32 v130, v130
  v_exp_f32 v131, v131
  v_exp_f32 v132, v132
  v_exp_f32 v133, v133
  v_mfma_f32_32x32x16_bf16 v[144:159], v[244:247], v[44:47], v[144:159]
  s_ff1_i32_b32 s37, s37
  s_bitset0_b32 s36, s37
  v_exp_f32 v134, v134
  v_exp_f32 v135, v135
  v_exp_f32 v136, v136
  v_exp_f32 v137, v137
  v_smfmac_f32_32x32x32_bf16 v[112:127], v[236:239], v[184:191], v9
  s_waitcnt vmcnt(8)
  s_lshl2_add_u32 s37, s37, s3
  v_exp_f32 v138, v138
  v_exp_f32 v139, v139
  v_exp_f32 v140, v140
  v_exp_f32 v141, v141
  v_smfmac_f32_32x32x32_bf16 v[64:79], v[248:251], v[128:135], v9
  s_mul_i32 s28, s37, 59136
  v_exp_f32 v142, v142
  v_exp_f32 v143, v143
  v_exp_f32 v144, v144
  v_exp_f32 v145, v145
  v_mfma_f32_32x32x16_bf16 v[160:175], v[240:243], v[48:51], 0
  s_add_u32 s30, s28, 15232
  v_exp_f32 v146, v146
  v_exp_f32 v147, v147
  v_exp_f32 v148, v148
  v_exp_f32 v149, v149
  v_mfma_f32_32x32x16_bf16 v[160:175], v[244:247], v[52:55], v[160:175]
  v_exp_f32 v150, v150
  v_exp_f32 v151, v151
  v_exp_f32 v152, v152
  v_exp_f32 v153, v153
  v_smfmac_f32_32x32x32_bf16 v[64:79], v[252:255], v[136:143], v9
  buffer_load_dwordx4 v[224:227], v24, s[20:23], s28 offen offset:0 sc1
  v_exp_f32 v154, v154
  v_exp_f32 v155, v155
  v_exp_f32 v156, v156
  v_exp_f32 v157, v157
  v_smfmac_f32_32x32x32_bf16 v[80:95], v[248:251], v[144:151], v9
  buffer_load_dwordx4 v[228:231], v24, s[20:23], s28 offen offset:1024 sc1
  v_exp_f32 v158, v158
  v_exp_f32 v159, v159
  v_exp_f32 v160, v160
  v_exp_f32 v161, v161
  v_mfma_f32_32x32x16_bf16 v[176:191], v[240:243], v[56:59], 0
  v_exp_f32 v162, v162
  v_exp_f32 v163, v163
  v_exp_f32 v164, v164
  v_exp_f32 v165, v165
  v_mfma_f32_32x32x16_bf16 v[176:191], v[244:247], v[60:63], v[176:191]
  v_exp_f32 v166, v166
  v_exp_f32 v167, v167
  v_exp_f32 v168, v168
  v_exp_f32 v169, v169
  v_smfmac_f32_32x32x32_bf16 v[80:95], v[252:255], v[152:159], v9
  buffer_load_dwordx4 v[232:235], v30, s[20:23], s28 offen sc1
  v_exp_f32 v170, v170
  v_exp_f32 v171, v171
  v_exp_f32 v172, v172
  v_exp_f32 v173, v173
  v_smfmac_f32_32x32x32_bf16 v[96:111], v[248:251], v[160:167], v9
  buffer_load_dwordx4 v[236:239], v30, s[20:23], s30 offen sc1
  s_waitcnt vmcnt(10)
  v_exp_f32 v174, v174
  v_exp_f32 v175, v175
  v_exp_f32 v176, v176
  v_exp_f32 v177, v177
  v_mfma_f32_32x32x16_bf16 v[128:143], v[192:195], v[32:35], 0
  v_exp_f32 v178, v178
  v_exp_f32 v179, v179
  v_exp_f32 v180, v180
  v_exp_f32 v181, v181
  v_mfma_f32_32x32x16_bf16 v[128:143], v[196:199], v[36:39], v[128:143]
  v_exp_f32 v182, v182
  v_exp_f32 v183, v183
  v_exp_f32 v184, v184
  v_exp_f32 v185, v185
  v_smfmac_f32_32x32x32_bf16 v[96:111], v[252:255], v[168:175], v9
  v_exp_f32 v186, v186
  v_exp_f32 v187, v187
  v_exp_f32 v188, v188
  v_exp_f32 v189, v189
  v_smfmac_f32_32x32x32_bf16 v[112:127], v[248:251], v[176:183], v9
  v_exp_f32 v190, v190
  v_exp_f32 v191, v191
Latt_in:
  v_exp_f32 v128, v128
  v_exp_f32 v129, v129
  v_mfma_f32_32x32x16_bf16 v[144:159], v[192:195], v[40:43], 0
  s_and_b32 s37, s36, s35
  s_cbranch_scc0 Lslow0
Lsr0:
  v_exp_f32 v130, v130
  v_exp_f32 v131, v131
  v_exp_f32 v132, v132
  v_exp_f32 v133, v133
  v_mfma_f32_32x32x16_bf16 v[144:159], v[196:199], v[44:47], v[144:159]
  s_ff1_i32_b32 s37, s37
  s_bitset0_b32 s36, s37
  v_exp_f32 v134, v134
  v_exp_f32 v135, v135
  v_exp_f32 v136, v136
  v_exp_f32 v137, v137
  v_smfmac_f32_32x32x32_bf16 v[112:127], v[252:255], v[184:191], v9
  s_waitcnt vmcnt(8)
  s_cmp_eq_u32 s35, -1
  s_cbranch_scc1 Lnp
  buffer_load_dword v31, v22, s[16:19], 0 offen sc1
Lnp:
  s_lshl2_add_u32 s37, s37, s3
  v_exp_f32 v138, v138
  v_exp_f32 v139, v139
  v_exp_f32 v140, v140
  v_exp_f32 v141, v141
  v_smfmac_f32_32x32x32_bf16 v[64:79], v[200:203], v[128:135], v9
  s_mul_i32 s28, s37, 59136
  v_exp_f32 v142, v142
  v_exp_f32 v143, v143
  v_exp_f32 v144, v144
  v_exp_f32 v145, v145
  v_mfma_f32_32x32x16_bf16 v[160:175], v[192:195], v[48:51], 0
  s_add_u32 s30, s28, 15232
  v_exp_f32 v146, v146
  v_exp_f32 v147, v147
  v_exp_f32 v148, v148
  v_exp_f32 v149, v149
  v_mfma_f32_32x32x16_bf16 v[160:175], v[196:199], v[52:55], v[160:175]
  v_exp_f32 v150, v150
  v_exp_f32 v151, v151
  v_exp_f32 v152, v152
  v_exp_f32 v153, v153
  v_smfmac_f32_32x32x32_bf16 v[64:79], v[204:207], v[136:143], v9
  buffer_load_dwordx4 v[240:243], v24, s[20:23], s28 offen offset:0 sc1
  v_exp_f32 v154, v154
  v_exp_f32 v155, v155
  v_exp_f32 v156, v156
  v_exp_f32 v157, v157
  v_smfmac_f32_32x32x32_bf16 v[80:95], v[200:203], v[144:151], v9
  buffer_load_dwordx4 v[244:247], v24, s[20:23], s28 offen offset:1024 sc1
  v_exp_f32 v158, v158
  v_exp_f32 v159, v159
  v_exp_f32 v160, v160
  v_exp_f32 v161, v161
  v_mfma_f32_32x32x16_bf16 v[176:191], v[192:195], v[56:59], 0
  v_exp_f32 v162, v162
  v_exp_f32 v163, v163
  v_exp_f32 v164, v164
  v_exp_f32 v165, v165
  v_mfma_f32_32x32x16_bf16 v[176:191], v[196:199], v[60:63], v[176:191]
  v_exp_f32 v166, v166
  v_exp_f32 v167, v167
  v_exp_f32 v168, v168
  v_exp_f32 v169, v169
  v_smfmac_f32_32x32x32_bf16 v[80:95], v[204:207], v[152:159], v9
  buffer_load_dwordx4 v[248:251], v30, s[20:23], s28 offen sc1
  v_exp_f32 v170, v170
  v_exp_f32 v171, v171
  v_exp_f32 v172, v172
  v_exp_f32 v173, v173
  v_smfmac_f32_32x32x32_bf16 v[96:111], v[200:203], v[160:167], v9
  buffer_load_dwordx4 v[252:255], v30, s[20:23], s30 offen sc1
  s_waitcnt vmcnt(10)
  v_exp_f32 v174, v174
  v_exp_f32 v175, v175
  v_exp_f32 v176, v176
  v_exp_f32 v177, v177
  v_mfma_f32_32x32x16_bf16 v[128:143], v[208:211], v[32:35], 0
  v_exp_f32 v178, v178
  v_exp_f32 v179, v179
  v_exp_f32 v180, v180
  v_exp_f32 v181, v181
  v_mfma_f32_32x32x16_bf16 v[128:143], v[212:215], v[36:39], v[128:143]
  v_exp_f32 v182, v182
  v_exp_f32 v183, v183
  v_exp_f32 v184, v184
  v_exp_f32 v185, v185
  v_smfmac_f32_32x32x32_bf16 v[96:111], v[204:207], v[168:175], v9
  v_exp_f32 v186, v186
  v_exp_f32 v187, v187
  v_exp_f32 v188, v188
  v_exp_f32 v189, v189
  v_smfmac_f32_32x32x32_bf16 v[112:127], v[200:203], v[176:183], v9
  v_exp_f32 v190, v190
  v_exp_f32 v191, v191
Latt_1:
  v_exp_f32 v128, v128
  v_exp_f32 v129, v129
  v_mfma_f32_32x32x16_bf16 v[144:159], v[208:211], v[40:43], 0
  s_and_b32 s37, s36, s35
  s_cbranch_scc0 Lslow1
Lsr1:
  v_exp_f32 v130, v130
  v_exp_f32 v131, v131
  v_exp_f32 v132, v132
  v_exp_f32 v133, v133
  v_mfma_f32_32x32x16_bf16 v[144:159], v[212:215], v[44:47], v[144:159]
  s_ff1_i32_b32 s37, s37
  s_bitset0_b32 s36, s37
  v_exp_f32 v134, v134
  v_exp_f32 v135, v135
  v_exp_f32 v136, v136
  v_exp_f32 v137, v137
  v_smfmac_f32_32x32x32_bf16 v[112:127], v[204:207], v[184:191], v9
  s_waitcnt vmcnt(8)
  s_lshl2_add_u32 s37, s37, s3
  v_exp_f32 v138, v138
  v_exp_f32 v139, v139
  v_exp_f32 v140, v140
  v_exp_f32 v141, v141
  v_smfmac_f32_32x32x32_bf16 v[64:79], v[216:219], v[128:135], v9
  s_mul_i32 s28, s37, 59136
  v_exp_f32 v142, v142
  v_exp_f32 v143, v143
  v_exp_f32 v144, v144
  v_exp_f32 v145, v145
  v_mfma_f32_32x32x16_bf16 v[160:175], v[208:211], v[48:51], 0
  s_add_u32 s30, s28, 15232
  v_exp_f32 v146, v146
  v_exp_f32 v147, v147
  v_exp_f32 v148, v148
  v_exp_f32 v149, v149
  v_mfma_f32_32x32x16_bf16 v[160:175], v[212:215], v[52:55], v[160:175]
  v_exp_f32 v150, v150
  v_exp_f32 v151, v151
  v_exp_f32 v152, v152
  v_exp_f32 v153, v153
  v_smfmac_f32_32x32x32_bf16 v[64:79], v[220:223], v[136:143], v9
  buffer_load_dwordx4 v[192:195], v24, s[20:23], s28 offen offset:0 sc1
  v_exp_f32 v154, v154
  v_exp_f32 v155, v155
  v_exp_f32 v156, v156
  v_exp_f32 v157, v157
  v_smfmac_f32_32x32x32_bf16 v[80:95], v[216:219], v[144:151], v9
  buffer_load_dwordx4 v[196:199], v24, s[20:23], s28 offen offset:1024 sc1
  v_exp_f32 v158, v158
  v_exp_f32 v159, v159
  v_exp_f32 v160, v160
  v_exp_f32 v161, v161
  v_mfma_f32_32x32x16_bf16 v[176:191], v[208:211], v[56:59], 0
  v_exp_f32 v162, v162
  v_exp_f32 v163, v163
  v_exp_f32 v164, v164
  v_exp_f32 v165, v165
  v_mfma_f32_32x32x16_bf16 v[176:191], v[212:215], v[60:63], v[176:191]
  v_exp_f32 v166, v166
  v_exp_f32 v167, v167
  v_exp_f32 v168, v168
  v_exp_f32 v169, v169
  v_smfmac_f32_32x32x32_bf16 v[80:95], v[220:223], v[152:159], v9
  buffer_load_dwordx4 v[200:203], v30, s[20:23], s28 offen sc1
  v_exp_f32 v170, v170
  v_exp_f32 v171, v171
  v_exp_f32 v172, v172
  v_exp_f32 v173, v173
  v_smfmac_f32_32x32x32_bf16 v[96:111], v[216:219], v[160:167], v9
  buffer_load_dwordx4 v[204:207], v30, s[20:23], s30 offen sc1
  s_waitcnt vmcnt(10)
  v_exp_f32 v174, v174
  v_exp_f32 v175, v175
  v_exp_f32 v176, v176
  v_exp_f32 v177, v177
  v_mfma_f32_32x32x16_bf16 v[128:143], v[224:227], v[32:35], 0
  v_exp_f32 v178, v178
  v_exp_f32 v179, v179
  v_exp_f32 v180, v180
  v_exp_f32 v181, v181
  v_mfma_f32_32x32x16_bf16 v[128:143], v[228:231], v[36:39], v[128:143]
  v_exp_f32 v182, v182
  v_exp_f32 v183, v183
  v_exp_f32 v184, v184
  v_exp_f32 v185, v185
  v_smfmac_f32_32x32x32_bf16 v[96:111], v[220:223], v[168:175], v9
  s_cmp_eq_u32 s35, -1
  s_cbranch_scc1 Lnu
  s_waitcnt vmcnt(8)
  v_cmp_eq_u32 vcc, s62, v31
  s_and_b32 s35, vcc_lo, vcc_hi
  s_lshr_b32 s63, s35, 16
  s_and_b32 s35, s35, s63
  s_cmp_eq_u32 s35, 0xffff
  s_cselect_b32 s35, -1, s35
Lnu:
  v_exp_f32 v186, v186
  v_exp_f32 v187, v187
  v_exp_f32 v188, v188
  v_exp_f32 v189, v189
  v_smfmac_f32_32x32x32_bf16 v[112:127], v[216:219], v[176:183], v9
  v_exp_f32 v190, v190
  v_exp_f32 v191, v191
  v_exp_f32 v128, v128
  v_exp_f32 v129, v129
  v_mfma_f32_32x32x16_bf16 v[144:159], v[224:227], v[40:43], 0
  s_and_b32 s37, s36, s35
  s_cbranch_scc0 Lslow2
Lsr2:
  v_exp_f32 v130, v130
  v_exp_f32 v131, v131
  v_exp_f32 v132, v132
  v_exp_f32 v133, v133
  v_mfma_f32_32x32x16_bf16 v[144:159], v[228:231], v[44:47], v[144:159]
  s_ff1_i32_b32 s37, s37
  s_bitset0_b32 s36, s37
  v_exp_f32 v134, v134
  v_exp_f32 v135, v135
  v_exp_f32 v136, v136
  v_exp_f32 v137, v137
  v_smfmac_f32_32x32x32_bf16 v[112:127], v[220:223], v[184:191], v9
  s_waitcnt vmcnt(8)
  s_lshl2_add_u32 s37, s37, s3
  v_exp_f32 v138, v138
  v_exp_f32 v139, v139
  v_exp_f32 v140, v140
  v_exp_f32 v141, v141
  v_smfmac_f32_32x32x32_bf16 v[64:79], v[232:235], v[128:135], v9
  s_mul_i32 s28, s37, 59136
  v_exp_f32 v142, v142
  v_exp_f32 v143, v143
  v_exp_f32 v144, v144
  v_exp_f32 v145, v145
  v_mfma_f32_32x32x16_bf16 v[160:175], v[224:227], v[48:51], 0
  s_add_u32 s30, s28, 15232
  v_exp_f32 v146, v146
  v_exp_f32 v147, v147
  v_exp_f32 v148, v148
  v_exp_f32 v149, v149
  v_mfma_f32_32x32x16_bf16 v[160:175], v[228:231], v[52:55], v[160:175]
  v_exp_f32 v150, v150
  v_exp_f32 v151, v151
  v_exp_f32 v152, v152
  v_exp_f32 v153, v153
  v_smfmac_f32_32x32x32_bf16 v[64:79], v[236:239], v[136:143], v9
  buffer_load_dwordx4 v[208:211], v24, s[20:23], s28 offen offset:0 sc1
  v_exp_f32 v154, v154
  v_exp_f32 v155, v155
  v_exp_f32 v156, v156
  v_exp_f32 v157, v157
  v_smfmac_f32_32x32x32_bf16 v[80:95], v[232:235], v[144:151], v9
  buffer_load_dwordx4 v[212:215], v24, s[20:23], s28 offen offset:1024 sc1
  v_exp_f32 v158, v158
  v_exp_f32 v159, v159
  v_exp_f32 v160, v160
  v_exp_f32 v161, v161
  v_mfma_f32_32x32x16_bf16 v[176:191], v[224:227], v[56:59], 0
  v_exp_f32 v162, v162
  v_exp_f32 v163, v163
  v_exp_f32 v164, v164
  v_exp_f32 v165, v165
  v_mfma_f32_32x32x16_bf16 v[176:191], v[228:231], v[60:63], v[176:191]
  v_exp_f32 v166, v166
  v_exp_f32 v167, v167
  v_exp_f32 v168, v168
  v_exp_f32 v169, v169
  v_smfmac_f32_32x32x32_bf16 v[80:95], v[236:239], v[152:159], v9
  buffer_load_dwordx4 v[216:219], v30, s[20:23], s28 offen sc1
  v_exp_f32 v170, v170
  v_exp_f32 v171, v171
  v_exp_f32 v172, v172
  v_exp_f32 v173, v173
  v_smfmac_f32_32x32x32_bf16 v[96:111], v[232:235], v[160:167], v9
  buffer_load_dwordx4 v[220:223], v30, s[20:23], s30 offen sc1
  s_waitcnt vmcnt(10)
  v_exp_f32 v174, v174
  v_exp_f32 v175, v175
  v_exp_f32 v176, v176
  v_exp_f32 v177, v177
  v_mfma_f32_32x32x16_bf16 v[128:143], v[240:243], v[32:35], 0
  ds_read_b32 v23, v13 offset:224
  v_exp_f32 v178, v178
  v_exp_f32 v179, v179
  v_exp_f32 v180, v180
  v_exp_f32 v181, v181
  v_mfma_f32_32x32x16_bf16 v[128:143], v[244:247], v[36:39], v[128:143]
  v_exp_f32 v182, v182
  v_exp_f32 v183, v183
  v_exp_f32 v184, v184
  v_exp_f32 v185, v185
  v_smfmac_f32_32x32x32_bf16 v[96:111], v[236:239], v[168:175], v9
  s_add_u32 s29, s29, 1
  v_exp_f32 v186, v186
  v_exp_f32 v187, v187
  v_exp_f32 v188, v188
  v_exp_f32 v189, v189
  v_smfmac_f32_32x32x32_bf16 v[112:127], v[232:235], v[176:183], v9
  s_cmp_lt_u32 s29, 4
  v_exp_f32 v190, v190
  v_exp_f32 v191, v191
  s_cbranch_scc1 Latt
  s_waitcnt lgkmcnt(0)
  v_readfirstlane_b32 s65, v23
  s_cmp_ge_u32 s65, 4
  s_cbranch_scc1 Lsx_17
  s_mov_b32 s64, 0
Lsp_16:
  ds_read_b32 v23, v13 offset:224
  s_add_u32 s64, s64, 1
  s_waitcnt lgkmcnt(0)
  v_readfirstlane_b32 s65, v23
  s_cmp_ge_u32 s65, 4
  s_cbranch_scc1 Lsx_17
  s_cmp_lt_u32 s64, 200000
  s_cbranch_scc1 Lsp_16
Lsx_17:
  v_exp_f32 v128, v128
  v_exp_f32 v129, v129
  v_mfma_f32_32x32x16_bf16 v[144:159], v[240:243], v[40:43], 0
  v_exp_f32 v130, v130
  v_exp_f32 v131, v131
  v_exp_f32 v132, v132
  v_exp_f32 v133, v133
  v_mfma_f32_32x32x16_bf16 v[144:159], v[244:247], v[44:47], v[144:159]
  v_exp_f32 v134, v134
  v_exp_f32 v135, v135
  v_exp_f32 v136, v136
  v_exp_f32 v137, v137
  v_smfmac_f32_32x32x32_bf16 v[112:127], v[236:239], v[184:191], v9
  v_exp_f32 v138, v138
  v_exp_f32 v139, v139
  v_exp_f32 v140, v140
  v_exp_f32 v141, v141
  s_waitcnt vmcnt(9)
  v_smfmac_f32_32x32x32_bf16 v[64:79], v[248:251], v[128:135], v9
  v_exp_f32 v142, v142
  v_exp_f32 v143, v143
  v_exp_f32 v144, v144
  v_exp_f32 v145, v145
  v_mfma_f32_32x32x16_bf16 v[160:175], v[240:243], v[48:51], 0
  v_exp_f32 v146, v146
  v_exp_f32 v147, v147
  v_exp_f32 v148, v148
  v_exp_f32 v149, v149
  v_mfma_f32_32x32x16_bf16 v[160:175], v[244:247], v[52:55], v[160:175]
  v_exp_f32 v150, v150
  v_exp_f32 v151, v151
  v_exp_f32 v152, v152
  v_exp_f32 v153, v153
  s_waitcnt vmcnt(8)
  v_smfmac_f32_32x32x32_bf16 v[64:79], v[252:255], v[136:143], v9
  v_exp_f32 v154, v154
  v_exp_f32 v155, v155
  v_exp_f32 v156, v156
  v_exp_f32 v157, v157
  v_smfmac_f32_32x32x32_bf16 v[80:95], v[248:251], v[144:151], v9
  v_exp_f32 v158, v158
  v_exp_f32 v159, v159
  v_exp_f32 v160, v160
  v_exp_f32 v161, v161
  v_mfma_f32_32x32x16_bf16 v[176:191], v[240:243], v[56:59], 0
  s_nop 1
  ds_write_b128 v5, v[64:67] offset:0
  v_exp_f32 v162, v162
  v_exp_f32 v163, v163
  v_exp_f32 v164, v164
  v_exp_f32 v165, v165
  v_mfma_f32_32x32x16_bf16 v[176:191], v[244:247], v[60:63], v[176:191]
  ds_write_b128 v5, v[68:71] offset:1024
  v_exp_f32 v166, v166
  v_exp_f32 v167, v167
  v_exp_f32 v168, v168
  v_exp_f32 v169, v169
  v_smfmac_f32_32x32x32_bf16 v[80:95], v[252:255], v[152:159], v9
  ds_write_b128 v5, v[72:75] offset:2048
  v_exp_f32 v170, v170
  v_exp_f32 v171, v171
  v_exp_f32 v172, v172
  v_exp_f32 v173, v173
  v_smfmac_f32_32x32x32_bf16 v[96:111], v[248:251], v[160:167], v9
  ds_write_b96 v5, v[76:78] offset:3072
  v_exp_f32 v174, v174
  v_exp_f32 v175, v175
  v_exp_f32 v176, v176
  v_exp_f32 v177, v177
  v_smfmac_f32_32x32x32_bf16 v[96:111], v[252:255], v[168:175], v9
  ds_write_b128 v6, v[80:83] offset:0
  v_exp_f32 v178, v178
  v_exp_f32 v179, v179
  ds_write_b128 v6, v[84:87] offset:1024
  v_exp_f32 v180, v180
  v_exp_f32 v181, v181
  ds_write_b128 v6, v[88:91] offset:2048
  v_exp_f32 v182, v182
  v_exp_f32 v183, v183
  ds_write_b96 v6, v[92:94] offset:3072
  v_exp_f32 v184, v184
  v_exp_f32 v185, v185
  v_smfmac_f32_32x32x32_bf16 v[112:127], v[248:251], v[176:183], v9
  ds_write_b128 v7, v[96:99] offset:0
  v_exp_f32 v186, v186
  v_exp_f32 v187, v187
  ds_write_b128 v7, v[100:103] offset:1024
  v_exp_f32 v188, v188
  v_exp_f32 v189, v189
  ds_write_b128 v7, v[104:107] offset:2048
  v_exp_f32 v190, v190
  v_exp_f32 v191, v191
  ds_write_b96 v7, v[108:110] offset:3072
  s_nop 0
  v_smfmac_f32_32x32x32_bf16 v[112:127], v[252:255], v[184:191], v9
Lnrm0:
  s_waitcnt lgkmcnt(0)
  s_barrier
  ds_read_b128 v[64:67], v8 offset:0
  ds_read_b128 v[68:71], v8 offset:1024
  ds_read_b128 v[72:75], v8 offset:2048
  ds_read_b128 v[76:79], v8 offset:3072
  ds_read_b128 v[80:83], v8 offset:4096
  ds_read_b128 v[84:87], v8 offset:5120
  ds_read_b128 v[88:91], v8 offset:6144
  ds_read_b128 v[92:95], v8 offset:7168
  ds_read_b128 v[96:99], v8 offset:8192
  ds_read_b128 v[100:103], v8 offset:9216
  ds_read_b128 v[104:107], v8 offset:10240
  ds_read_b128 v[108:111], v8 offset:11264
  s_mov_b32 s64, 0x1f800000
  s_mov_b32 s65, 0x5f800000
  s_waitcnt lgkmcnt(11)
  v_pk_add_f32 v[112:113], v[112:113], v[64:65]
  v_pk_add_f32 v[114:115], v[114:115], v[66:67]
  s_waitcnt lgkmcnt(10)
  v_pk_add_f32 v[116:117], v[116:117], v[68:69]
  v_pk_add_f32 v[118:119], v[118:119], v[70:71]
  s_waitcnt lgkmcnt(9)
  v_pk_add_f32 v[120:121], v[120:121], v[72:73]
  v_pk_add_f32 v[122:123], v[122:123], v[74:75]
  s_waitcnt lgkmcnt(8)
  v_pk_add_f32 v[124:125], v[124:125], v[76:77]
  v_pk_add_f32 v[126:127], v[126:127], v[78:79]
  s_waitcnt lgkmcnt(7)
  v_pk_add_f32 v[112:113], v[112:113], v[80:81]
  v_pk_add_f32 v[114:115], v[114:115], v[82:83]
  s_waitcnt lgkmcnt(6)
  v_pk_add_f32 v[116:117], v[116:117], v[84:85]
  v_pk_add_f32 v[118:119], v[118:119], v[86:87]
  s_waitcnt lgkmcnt(5)
  v_pk_add_f32 v[120:121], v[120:121], v[88:89]
  v_pk_add_f32 v[122:123], v[122:123], v[90:91]
  s_waitcnt lgkmcnt(4)
  v_pk_add_f32 v[124:125], v[124:125], v[92:93]
  v_pk_add_f32 v[126:127], v[126:127], v[94:95]
  s_waitcnt lgkmcnt(3)
  v_pk_add_f32 v[112:113], v[112:113], v[96:97]
  v_pk_add_f32 v[114:115], v[114:115], v[98:99]
  s_waitcnt lgkmcnt(2)
  v_pk_add_f32 v[116:117], v[116:117], v[100:101]
  v_pk_add_f32 v[118:119], v[118:119], v[102:103]
  s_waitcnt lgkmcnt(1)
  v_pk_add_f32 v[120:121], v[120:121], v[104:105]
  v_pk_add_f32 v[122:123], v[122:123], v[106:107]
  s_waitcnt lgkmcnt(0)
  v_pk_add_f32 v[124:125], v[124:125], v[108:109]
  v_pk_add_f32 v[126:127], v[126:127], v[110:111]
  v_cmp_le_f32 vcc, s64, v119
  v_cmp_ge_f32 s[64:65], s65, v119
  v_rcp_f32 v64, v119
  s_and_b64 vcc, vcc, s[64:65]
  s_cmp_eq_u64 vcc, -1
  s_cbranch_scc0 Lfallback
Lnorm:
  v_pk_mul_f32 v[112:113], v[112:113], v[64:65] op_sel_hi:[1,0]
  v_pk_mul_f32 v[114:115], v[114:115], v[64:65] op_sel_hi:[1,0]
  v_pk_mul_f32 v[116:117], v[116:117], v[64:65] op_sel_hi:[1,0]
  v_pk_mul_f32 v[118:119], v[118:119], v[64:65] op_sel_hi:[1,0]
  v_cvt_pk_bf16_f32 v160, v112, v113
  v_cvt_pk_bf16_f32 v161, v114, v115
  v_cvt_pk_bf16_f32 v162, v116, v117
  v_cvt_pk_bf16_f32 v163, v118, 1.0
  buffer_store_dwordx4 v[160:163], v18, s[16:19], s31 offen offset:0 sc1
  v_pk_mul_f32 v[120:121], v[120:121], v[64:65] op_sel_hi:[1,0]
  v_pk_mul_f32 v[122:123], v[122:123], v[64:65] op_sel_hi:[1,0]
  v_pk_mul_f32 v[124:125], v[124:125], v[64:65] op_sel_hi:[1,0]
  v_pk_mul_f32 v[126:127], v[126:127], v[64:65] op_sel_hi:[1,0]
  v_cvt_pk_bf16_f32 v164, v120, v121
  v_cvt_pk_bf16_f32 v165, v122, v123
  v_cvt_pk_bf16_f32 v166, v124, v125
  v_cvt_pk_bf16_f32 v167, v126, 1.0
  buffer_store_dwordx4 v[164:167], v18, s[16:19], s31 offen offset:1024 sc1
  s_barrier
Lxe:
Lend:
  s_endpgm
  .p2align 12
Lbx0:
  s_andn2_b32 s48, s7, 3
  s_mul_i32 s48, s48, 7
  s_add_u32 s48, s48, 28
  s_lshl_b32 s42, s6, 5
  s_cmp_eq_u32 s6, 7
  s_cselect_b32 s42, s48, s42
  s_lshl2_add_u32 s48, s6, 196
  s_cmp_ge_u32 s7, 28
  s_cselect_b32 s42, s48, s42
  s_cselect_b32 s45, 0x40000000, 0
  s_add_u32 s42, s42, s7
  s_lshl2_add_u32 s43, s42, s3
  s_mul_i32 s44, s3, 8704
  s_add_u32 s44, s44, 106496
  v_add_u32 v156, s44, v18
  v_add_u32 v157, s31, v18
  s_and_b32 s46, s43, 0x380
  s_lshl_b32 s48, s3, 5
  s_add_u32 s48, s48, s46
  s_lshl_b32 s48, s48, 6
  s_and_b32 s49, s42, 31
  s_add_u32 s48, s48, s49
  s_lshl_b32 s48, s48, 5
  s_add_u32 s48, s48, 12582912
  v_lshrrev_b32 v158, 1, v0
  v_lshl_add_u32 v158, v158, 10, s48
  v_and_b32 v172, 1, v0
  v_lshl_add_u32 v158, v172, 4, v158
  s_lshl_b32 s48, s43, 11
  s_add_u32 s48, s48, 12582912
  s_or_b32 s48, s48, s45
  v_add_u32 v159, s48, v18
  s_and_b32 s47, s43, 127
  s_mul_i32 s47, s47, 28672
  s_add_u32 s47, s47, s46
  s_or_b32 s47, s47, s45
  s_lshl_b32 s48, s3, 11
  v_and_b32 v172, 1, v0
  v_mul_u32_u24 v168, 32832, v172
  v_add3_u32 v168, v168, v18, s48
  s_add_u32 s48, s48, 114688
  v_add_u32 v164, s48, v18
  v_bfe_u32 v173, v0, 2, 2
  v_lshrrev_b32 v174, 4, v0
  v_lshl_add_u32 v175, v173, 1, v172
  v_lshl_add_u32 v175, v174, 4, v175
  v_bfe_u32 v176, v0, 1, 1
  v_lshl_add_u32 v175, v176, 7, v175
  v_lshl_add_u32 v165, v175, 3, s48
  v_and_b32 v175, 15, v0
  v_mul_u32_u24 v175, 1792, v175
  v_lshl_add_u32 v170, v174, 4, v175
  v_xor_b32 v175, v173, v174
  v_mul_u32_u24 v174, 896, v174
  s_branch Lbx0_r
Lbx1:
  v_lshl_add_u32 v174, v175, 6, v174
  v_and_b32 v177, 3, v0
  v_lshl_add_u32 v174, v177, 4, v174
  s_and_b32 s40, s4, 3
  s_cmp_eq_u32 s40, 3
  s_cselect_b32 s48, 2, 0
  v_and_b32 v175, s48, v175
  v_lshl_add_u32 v166, v175, 27, v174
  v_lshlrev_b32 v172, 4, v172
  v_lshl_add_u32 v172, v176, 3, v172
  v_and_b32 v174, 16, v0
  v_lshl_add_u32 v172, v174, 1, v172
  v_mad_u32_u24 v174, v15, 7, v173
  v_min_u32 v173, 2, v173
  v_mad_u32_u24 v173, v15, 7, v173
  v_bitop3_b32 v176, s3, v174, 3 bitop3:0x28
  v_lshl_add_u32 v160, v174, 8, v172
  v_lshl_add_u32 v160, v176, 6, v160
  v_add_u32 v175, 4, v173
  v_bitop3_b32 v176, s3, v175, 3 bitop3:0x28
  v_lshl_add_u32 v161, v175, 8, v172
  v_lshl_add_u32 v161, v176, 6, v161
  v_add_u32 v175, 14, v174
  v_bitop3_b32 v176, s3, v175, 3 bitop3:0x28
  v_lshl_add_u32 v162, v175, 8, v172
  v_lshl_add_u32 v162, v176, 6, v162
  v_add_u32 v175, 18, v173
  v_bitop3_b32 v176, s3, v175, 3 bitop3:0x28
  v_lshl_add_u32 v163, v175, 8, v172
  v_lshl_add_u32 v163, v176, 6, v163
  s_and_b32 s48, s6, 6
  s_and_b32 s49, s5, 3
  v_bfe_u32 v172, v0, 3, 1
  v_add_u32 v172, s48, v172
  s_add_u32 s48, s49, 224
  v_lshl_add_u32 v173, v172, 2, s48
  s_mul_i32 s49, s49, 7
  v_and_b32 v174, 7, v0
  v_add_u32 v174, s49, v174
  v_and_b32 v175, 28, v174
  v_mad_u32_u24 v175, v175, 7, 28
  v_cmp_eq_u32 vcc, 7, v172
  v_lshlrev_b32 v172, 5, v172
  s_nop 0
  v_cndmask_b32 v172, v172, v175, vcc
  v_add_u32 v172, v172, v174
  s_and_b32 s48, s42, 0xe0
  s_sub_u32 s48, s48, 32
  s_mov_b32 exec_lo, 0x80808080
  v_mov_b32 v172, v173
  s_mov_b32 exec_lo, 0
  v_add_u32 v172, s48, v0
  s_mov_b64 exec, -1
  s_mov_b32 s48, 131072
  v_lshl_add_u32 v167, v172, 7, s48
  v_add_u32 v172, 114688, v18
  s_lshl_b32 s49, s3, 13
  v_add_u32 v169, s49, v172
  v_and_b32 v172, 31, v0
  v_mul_u32_u24 v172, 1792, v172
  v_lshl_add_u32 v171, v15, 4, v172
  v_add_u32 v170, s47, v170
  ds_write_b128 v156, v[156:159] offset:4096
  ds_write_b128 v156, v[160:163] offset:5120
  ds_write_b128 v156, v[164:167] offset:6144
  ds_write_b128 v156, v[168:171] offset:7168
  s_mov_b64 exec, 1
  ds_add_u32 v13, v12 offset:48
  s_mov_b64 exec, -1
  s_branch Lbx1_r
La_head:
  s_lshr_b32 s28, s3, 1
  v_lshlrev_b32 v7, 4, v0
  s_movk_i32 s63, 0x3f80
  s_mov_b32 s64, 3
  s_mov_b32 s65, 0x30000
  v_lshlrev_b32 v7, v7, s63
  v_cndmask_b32 v96, v16, v7, s[64:65]
  s_lshl_b64 s[64:65], s[64:65], 2
  v_cndmask_b32 v97, v16, v7, s[64:65]
  s_lshl_b64 s[64:65], s[64:65], 2
  v_cndmask_b32 v98, v16, v7, s[64:65]
  s_lshl_b64 s[64:65], s[64:65], 2
  v_cndmask_b32 v99, v16, v7, s[64:65]
  s_lshl_b64 s[64:65], s[64:65], 2
  v_cndmask_b32 v100, v16, v7, s[64:65]
  s_lshl_b64 s[64:65], s[64:65], 2
  v_cndmask_b32 v101, v16, v7, s[64:65]
  s_lshl_b64 s[64:65], s[64:65], 2
  v_cndmask_b32 v102, v16, v7, s[64:65]
  s_lshl_b64 s[64:65], s[64:65], 2
  v_cndmask_b32 v103, v16, v7, s[64:65]
La_h0:
  s_setprio 3
  s_lshl_b32 s63, s28, 4
  s_waitcnt lgkmcnt(0)
  s_lshr_b32 s63, s50, s63
  s_lshl_b32 s63, s63, 16
  s_mov_b32 s64, 0x3fb8aa3b
  s_mov_b32 s65, 0x32a57060
  v_mov_b32 v1, s63
  v_mul_f32 v5, s64, v1
  v_fma_f32 v4, v1, s64, -v5
  v_fma_f32 v4, v1, s65, v4
  v_exp_f32 v5, v5
  v_mul_f32 v4, 0x3f317218, v4
  v_fma_f32 v5, v5, v4, v5
  v_cvt_pk_bf16_f32 v5, v5, v5
  v_and_b32 v26, 0xffff0000, v5
  s_setprio 1
  s_waitcnt vmcnt(5)
  v_lshlrev_b32 v28, 16, v20
  v_and_b32 v50, 0xffff0000, v20
  s_waitcnt vmcnt(4)
  v_lshlrev_b32 v29, 16, v21
  v_and_b32 v51, 0xffff0000, v21
  v_mul_f32 v28, v26, v28
  v_mul_f32 v50, v26, v50
  v_mul_f32 v29, v26, v29
  v_mul_f32 v51, v26, v51
  v_mul_f32 v28, s64, v28
  v_mul_f32 v50, s64, v50
  v_mul_f32 v29, 0.15915494, v29
  v_mul_f32 v51, 0.15915494, v51
  v_mul_f32 v48, 0x41000000, v28
  v_mul_f32 v70, 0x41000000, v50
  v_mul_f32 v49, 0x41000000, v29
  v_mul_f32 v71, 0x41000000, v51
  v_exp_f32 v48, v48
  v_exp_f32 v70, v70
  v_fract_f32 v49, v49
  v_fract_f32 v71, v71
  v_cos_f32 v40, v49
  v_cos_f32 v62, v71
  v_sin_f32 v41, v49
  v_sin_f32 v63, v71
  v_mul_f32 v40, v40, v48
  v_mul_f32 v62, v62, v70
  v_mul_f32 v41, v41, v48
  v_mul_f32 v63, v63, v70
  v_pk_mul_f32 v[42:43], v[40:41], v[40:41] op_sel:[0,0] op_sel_hi:[1,0]
  v_pk_fma_f32 v[42:43], v[40:41], v[40:41], v[42:43] op_sel:[1,1,0] op_sel_hi:[0,1,1] neg_lo:[1,0,0]
  v_pk_mul_f32 v[122:123], v[40:41], v[42:43] op_sel:[0,0] op_sel_hi:[1,0]
  v_pk_fma_f32 v[122:123], v[40:41], v[42:43], v[122:123] op_sel:[1,1,0] op_sel_hi:[0,1,1] neg_lo:[1,0,0]
  v_pk_mul_f32 v[76:77], v[42:43], v[42:43] op_sel:[0,0] op_sel_hi:[1,0]
  v_pk_mul_f32 v[124:125], v[122:123], v[42:43] op_sel:[0,0] op_sel_hi:[1,0]
  v_pk_fma_f32 v[76:77], v[42:43], v[42:43], v[76:77] op_sel:[1,1,0] op_sel_hi:[0,1,1] neg_lo:[1,0,0]
  v_pk_fma_f32 v[124:125], v[122:123], v[42:43], v[124:125] op_sel:[1,1,0] op_sel_hi:[0,1,1] neg_lo:[1,0,0]
  v_pk_mul_f32 v[78:79], v[76:77], v[42:43] op_sel:[0,0] op_sel_hi:[1,0]
  v_pk_mul_f32 v[126:127], v[124:125], v[42:43] op_sel:[0,0] op_sel_hi:[1,0]
  v_pk_fma_f32 v[78:79], v[76:77], v[42:43], v[78:79] op_sel:[1,1,0] op_sel_hi:[0,1,1] neg_lo:[1,0,0]
  v_pk_fma_f32 v[126:127], v[124:125], v[42:43], v[126:127] op_sel:[1,1,0] op_sel_hi:[0,1,1] neg_lo:[1,0,0]
  v_cvt_pk_bf16_f32 v104, 1.0, v40
  v_cvt_pk_bf16_f32 v105, v42, v122
  v_cvt_pk_bf16_f32 v106, v76, v124
  v_cvt_pk_bf16_f32 v107, v78, v126
  v_cvt_pk_bf16_f32 v108, 0, v41
  v_cvt_pk_bf16_f32 v109, v43, v123
  v_cvt_pk_bf16_f32 v110, v77, v125
  v_cvt_pk_bf16_f32 v111, v79, v127
  v_pk_mul_f32 v[72:73], v[78:79], v[42:43] op_sel:[0,0] op_sel_hi:[1,0]
  v_pk_mul_f32 v[120:121], v[126:127], v[42:43] op_sel:[0,0] op_sel_hi:[1,0]
  v_pk_fma_f32 v[72:73], v[78:79], v[42:43], v[72:73] op_sel:[1,1,0] op_sel_hi:[0,1,1] neg_lo:[1,0,0]
  v_pk_fma_f32 v[120:121], v[126:127], v[42:43], v[120:121] op_sel:[1,1,0] op_sel_hi:[0,1,1] neg_lo:[1,0,0]
  v_pk_mul_f32 v[74:75], v[72:73], v[42:43] op_sel:[0,0] op_sel_hi:[1,0]
  v_pk_mul_f32 v[122:123], v[120:121], v[42:43] op_sel:[0,0] op_sel_hi:[1,0]
  v_pk_fma_f32 v[74:75], v[72:73], v[42:43], v[74:75] op_sel:[1,1,0] op_sel_hi:[0,1,1] neg_lo:[1,0,0]
  v_pk_fma_f32 v[122:123], v[120:121], v[42:43], v[122:123] op_sel:[1,1,0] op_sel_hi:[0,1,1] neg_lo:[1,0,0]
  v_pk_mul_f32 v[76:77], v[74:75], v[42:43] op_sel:[0,0] op_sel_hi:[1,0]
  v_pk_mul_f32 v[124:125], v[122:123], v[42:43] op_sel:[0,0] op_sel_hi:[1,0]
  v_pk_fma_f32 v[76:77], v[74:75], v[42:43], v[76:77] op_sel:[1,1,0] op_sel_hi:[0,1,1] neg_lo:[1,0,0]
  v_pk_fma_f32 v[124:125], v[122:123], v[42:43], v[124:125] op_sel:[1,1,0] op_sel_hi:[0,1,1] neg_lo:[1,0,0]
  v_pk_mul_f32 v[78:79], v[76:77], v[42:43] op_sel:[0,0] op_sel_hi:[1,0]
  v_pk_mul_f32 v[126:127], v[124:125], v[42:43] op_sel:[0,0] op_sel_hi:[1,0]
  v_pk_fma_f32 v[78:79], v[76:77], v[42:43], v[78:79] op_sel:[1,1,0] op_sel_hi:[0,1,1] neg_lo:[1,0,0]
  v_pk_fma_f32 v[126:127], v[124:125], v[42:43], v[126:127] op_sel:[1,1,0] op_sel_hi:[0,1,1] neg_lo:[1,0,0]
  v_mfma_f32_32x32x16_bf16 v[128:143], v[104:107], v[96:99], 0
  v_mul_f32 v48, 0x43800000, v28
  v_exp_f32 v46, v28
  v_mul_f32 v49, 0x43800000, v29
  v_fract_f32 v47, v29
  v_exp_f32 v48, v48
  v_cos_f32 v34, v47
  v_mfma_f32_32x32x16_bf16 v[144:159], v[108:111], v[96:99], 0
  v_fract_f32 v49, v49
  v_cvt_pk_bf16_f32 v112, v72, v120
  v_cvt_pk_bf16_f32 v113, v74, v122
  v_cvt_pk_bf16_f32 v114, v76, v124
  v_cvt_pk_bf16_f32 v115, v78, v126
  v_cvt_pk_bf16_f32 v116, v73, v121
  v_cvt_pk_bf16_f32 v117, v75, v123
  v_cvt_pk_bf16_f32 v118, v77, v125
  v_cvt_pk_bf16_f32 v119, v79, v127
  v_pk_mul_f32 v[72:73], v[78:79], v[42:43] op_sel:[0,0] op_sel_hi:[1,0]
  v_pk_mul_f32 v[120:121], v[126:127], v[42:43] op_sel:[0,0] op_sel_hi:[1,0]
  v_pk_fma_f32 v[72:73], v[78:79], v[42:43], v[72:73] op_sel:[1,1,0] op_sel_hi:[0,1,1] neg_lo:[1,0,0]
  v_pk_fma_f32 v[120:121], v[126:127], v[42:43], v[120:121] op_sel:[1,1,0] op_sel_hi:[0,1,1] neg_lo:[1,0,0]
  v_pk_mul_f32 v[74:75], v[72:73], v[42:43] op_sel:[0,0] op_sel_hi:[1,0]
  v_pk_mul_f32 v[122:123], v[120:121], v[42:43] op_sel:[0,0] op_sel_hi:[1,0]
  v_pk_fma_f32 v[74:75], v[72:73], v[42:43], v[74:75] op_sel:[1,1,0] op_sel_hi:[0,1,1] neg_lo:[1,0,0]
  v_pk_fma_f32 v[122:123], v[120:121], v[42:43], v[122:123] op_sel:[1,1,0] op_sel_hi:[0,1,1] neg_lo:[1,0,0]
  v_pk_mul_f32 v[76:77], v[74:75], v[42:43] op_sel:[0,0] op_sel_hi:[1,0]
  v_pk_mul_f32 v[124:125], v[122:123], v[42:43] op_sel:[0,0] op_sel_hi:[1,0]
  v_pk_fma_f32 v[76:77], v[74:75], v[42:43], v[76:77] op_sel:[1,1,0] op_sel_hi:[0,1,1] neg_lo:[1,0,0]
  v_pk_fma_f32 v[124:125], v[122:123], v[42:43], v[124:125] op_sel:[1,1,0] op_sel_hi:[0,1,1] neg_lo:[1,0,0]
  v_pk_mul_f32 v[78:79], v[76:77], v[42:43] op_sel:[0,0] op_sel_hi:[1,0]
  v_pk_mul_f32 v[126:127], v[124:125], v[42:43] op_sel:[0,0] op_sel_hi:[1,0]
  v_pk_fma_f32 v[78:79], v[76:77], v[42:43], v[78:79] op_sel:[1,1,0] op_sel_hi:[0,1,1] neg_lo:[1,0,0]
  v_pk_fma_f32 v[126:127], v[124:125], v[42:43], v[126:127] op_sel:[1,1,0] op_sel_hi:[0,1,1] neg_lo:[1,0,0]
  v_mfma_f32_32x32x16_bf16 v[128:143], v[112:115], v[100:103], v[128:143]
  v_sin_f32 v35, v47
  v_cos_f32 v44, v49
  v_mul_f32 v34, v34, v46
  v_sin_f32 v45, v49
  v_mul_f32 v35, v35, v46
  v_mul_f32 v44, v44, v48
  v_mfma_f32_32x32x16_bf16 v[144:159], v[116:119], v[100:103], v[144:159]
  v_mul_f32 v45, v45, v48
  v_cvt_pk_bf16_f32 v104, v72, v120
  v_cvt_pk_bf16_f32 v105, v74, v122
  v_cvt_pk_bf16_f32 v106, v76, v124
  v_cvt_pk_bf16_f32 v107, v78, v126
  v_cvt_pk_bf16_f32 v108, v73, v121
  v_cvt_pk_bf16_f32 v109, v75, v123
  v_cvt_pk_bf16_f32 v110, v77, v125
  v_cvt_pk_bf16_f32 v111, v79, v127
  v_pk_mul_f32 v[72:73], v[78:79], v[42:43] op_sel:[0,0] op_sel_hi:[1,0]
  v_pk_mul_f32 v[120:121], v[126:127], v[42:43] op_sel:[0,0] op_sel_hi:[1,0]
  v_pk_fma_f32 v[72:73], v[78:79], v[42:43], v[72:73] op_sel:[1,1,0] op_sel_hi:[0,1,1] neg_lo:[1,0,0]
  v_pk_fma_f32 v[120:121], v[126:127], v[42:43], v[120:121] op_sel:[1,1,0] op_sel_hi:[0,1,1] neg_lo:[1,0,0]
  v_pk_mul_f32 v[74:75], v[72:73], v[42:43] op_sel:[0,0] op_sel_hi:[1,0]
  v_pk_mul_f32 v[122:123], v[120:121], v[42:43] op_sel:[0,0] op_sel_hi:[1,0]
  v_pk_fma_f32 v[74:75], v[72:73], v[42:43], v[74:75] op_sel:[1,1,0] op_sel_hi:[0,1,1] neg_lo:[1,0,0]
  v_pk_fma_f32 v[122:123], v[120:121], v[42:43], v[122:123] op_sel:[1,1,0] op_sel_hi:[0,1,1] neg_lo:[1,0,0]
  v_pk_mul_f32 v[76:77], v[74:75], v[42:43] op_sel:[0,0] op_sel_hi:[1,0]
  v_pk_mul_f32 v[124:125], v[122:123], v[42:43] op_sel:[0,0] op_sel_hi:[1,0]
  v_pk_fma_f32 v[76:77], v[74:75], v[42:43], v[76:77] op_sel:[1,1,0] op_sel_hi:[0,1,1] neg_lo:[1,0,0]
  v_pk_fma_f32 v[124:125], v[122:123], v[42:43], v[124:125] op_sel:[1,1,0] op_sel_hi:[0,1,1] neg_lo:[1,0,0]
  v_pk_mul_f32 v[78:79], v[76:77], v[42:43] op_sel:[0,0] op_sel_hi:[1,0]
  v_pk_mul_f32 v[126:127], v[124:125], v[42:43] op_sel:[0,0] op_sel_hi:[1,0]
  v_pk_fma_f32 v[78:79], v[76:77], v[42:43], v[78:79] op_sel:[1,1,0] op_sel_hi:[0,1,1] neg_lo:[1,0,0]
  v_pk_fma_f32 v[126:127], v[124:125], v[42:43], v[126:127] op_sel:[1,1,0] op_sel_hi:[0,1,1] neg_lo:[1,0,0]
  v_mfma_f32_32x32x16_bf16 v[160:175], v[104:107], v[96:99], 0
  s_waitcnt vmcnt(3)
  v_lshlrev_b32 v30, 16, v22
  s_waitcnt vmcnt(2)
  v_lshlrev_b32 v31, 16, v23
  s_waitcnt vmcnt(1)
  v_lshlrev_b32 v32, 16, v24
  s_waitcnt vmcnt(0)
  v_lshlrev_b32 v33, 16, v25
  v_mul_f32 v30, v26, v30
  v_mul_f32 v31, v26, v31
  v_mfma_f32_32x32x16_bf16 v[176:191], v[108:111], v[96:99], 0
  v_cvt_pk_bf16_f32 v112, v72, v120
  v_cvt_pk_bf16_f32 v113, v74, v122
  v_cvt_pk_bf16_f32 v114, v76, v124
  v_cvt_pk_bf16_f32 v115, v78, v126
  v_cvt_pk_bf16_f32 v116, v73, v121
  v_cvt_pk_bf16_f32 v117, v75, v123
  v_cvt_pk_bf16_f32 v118, v77, v125
  v_cvt_pk_bf16_f32 v119, v79, v127
  v_cvt_pk_bf16_f32 v192, v128, v144
  v_cvt_pk_bf16_f32 v193, v129, v145
  v_cvt_pk_bf16_f32 v194, v130, v146
  v_cvt_pk_bf16_f32 v195, v131, v147
  v_cvt_pk_bf16_f32 v196, v132, v148
  v_cvt_pk_bf16_f32 v197, v133, v149
  v_cvt_pk_bf16_f32 v198, v134, v150
  v_cvt_pk_bf16_f32 v199, v135, v151
  v_pk_mul_f32 v[46:47], v[32:33], v[30:31] op_sel:[0,0] op_sel_hi:[1,0]
  v_pk_fma_f32 v[46:47], v[32:33], v[30:31], v[46:47] op_sel:[1,1,0] op_sel_hi:[0,1,1] neg_lo:[1,0,0]
  v_pk_mul_f32 v[36:37], v[34:35], v[34:35] op_sel:[0,0] op_sel_hi:[1,0]
  v_pk_fma_f32 v[36:37], v[34:35], v[34:35], v[36:37] op_sel:[1,1,0] op_sel_hi:[0,1,1] neg_lo:[1,0,0]
  v_pk_mul_f32 v[38:39], v[36:37], v[36:37] op_sel:[0,0] op_sel_hi:[1,0]
  v_pk_fma_f32 v[38:39], v[36:37], v[36:37], v[38:39] op_sel:[1,1,0] op_sel_hi:[0,1,1] neg_lo:[1,0,0]
  v_pk_mul_f32 v[120:121], v[46:47], v[34:35] op_sel:[0,0] op_sel_hi:[1,0]
  v_pk_mul_f32 v[74:75], v[46:47], v[36:37] op_sel:[0,0] op_sel_hi:[1,0]
  v_pk_fma_f32 v[120:121], v[46:47], v[34:35], v[120:121] op_sel:[1,1,0] op_sel_hi:[0,1,1] neg_lo:[1,0,0]
  v_pk_fma_f32 v[74:75], v[46:47], v[36:37], v[74:75] op_sel:[1,1,0] op_sel_hi:[0,1,1] neg_lo:[1,0,0]
  v_pk_mul_f32 v[122:123], v[120:121], v[36:37] op_sel:[0,0] op_sel_hi:[1,0]
  v_pk_mul_f32 v[76:77], v[74:75], v[36:37] op_sel:[0,0] op_sel_hi:[1,0]
  v_pk_fma_f32 v[122:123], v[120:121], v[36:37], v[122:123] op_sel:[1,1,0] op_sel_hi:[0,1,1] neg_lo:[1,0,0]
  v_pk_fma_f32 v[76:77], v[74:75], v[36:37], v[76:77] op_sel:[1,1,0] op_sel_hi:[0,1,1] neg_lo:[1,0,0]
  v_pk_mul_f32 v[124:125], v[122:123], v[36:37] op_sel:[0,0] op_sel_hi:[1,0]
  v_pk_mul_f32 v[78:79], v[76:77], v[36:37] op_sel:[0,0] op_sel_hi:[1,0]
  v_pk_fma_f32 v[124:125], v[122:123], v[36:37], v[124:125] op_sel:[1,1,0] op_sel_hi:[0,1,1] neg_lo:[1,0,0]
  v_pk_fma_f32 v[78:79], v[76:77], v[36:37], v[78:79] op_sel:[1,1,0] op_sel_hi:[0,1,1] neg_lo:[1,0,0]
  v_pk_mul_f32 v[126:127], v[124:125], v[36:37] op_sel:[0,0] op_sel_hi:[1,0]
  v_pk_mul_f32 v[48:49], v[46:47], v[44:45] op_sel:[0,0] op_sel_hi:[1,0]
  v_pk_fma_f32 v[126:127], v[124:125], v[36:37], v[126:127] op_sel:[1,1,0] op_sel_hi:[0,1,1] neg_lo:[1,0,0]
  v_pk_fma_f32 v[48:49], v[46:47], v[44:45], v[48:49] op_sel:[1,1,0] op_sel_hi:[0,1,1] neg_lo:[1,0,0]
  v_mfma_f32_32x32x16_bf16 v[160:175], v[112:115], v[100:103], v[160:175]
  v_cvt_pk_bf16_f32 v104, v46, v120
  v_cvt_pk_bf16_f32 v105, v74, v122
  v_cvt_pk_bf16_f32 v106, v76, v124
  v_cvt_pk_bf16_f32 v107, v78, v126
  v_cvt_pk_bf16_f32 v108, -v47, -v121
  v_cvt_pk_bf16_f32 v109, -v75, -v123
  v_mfma_f32_32x32x16_bf16 v[176:191], v[116:119], v[100:103], v[176:191]
  v_cvt_pk_bf16_f32 v110, -v77, -v125
  v_cvt_pk_bf16_f32 v111, -v79, -v127
  v_cvt_pk_bf16_f32 v200, v136, v152
  v_cvt_pk_bf16_f32 v201, v137, v153
  v_cvt_pk_bf16_f32 v202, v138, v154
  v_cvt_pk_bf16_f32 v203, v139, v155
  v_cvt_pk_bf16_f32 v204, v140, v156
  v_cvt_pk_bf16_f32 v205, v141, v157
  v_cvt_pk_bf16_f32 v206, v142, v158
  v_cvt_pk_bf16_f32 v207, v143, v159
  v_pk_mul_f32 v[72:73], v[48:49], v[36:37] op_sel:[0,0] op_sel_hi:[1,0]
  v_pk_mul_f32 v[74:75], v[48:49], v[38:39] op_sel:[0,0] op_sel_hi:[1,0]
  v_pk_fma_f32 v[72:73], v[48:49], v[36:37], v[72:73] op_sel:[1,1,0] op_sel_hi:[0,1,1] neg_lo:[1,0,0]
  v_pk_fma_f32 v[74:75], v[48:49], v[38:39], v[74:75] op_sel:[1,1,0] op_sel_hi:[0,1,1] neg_lo:[1,0,0]
  v_pk_mul_f32 v[76:77], v[72:73], v[38:39] op_sel:[0,0] op_sel_hi:[1,0]
  v_pk_mul_f32 v[78:79], v[74:75], v[38:39] op_sel:[0,0] op_sel_hi:[1,0]
  v_pk_fma_f32 v[76:77], v[72:73], v[38:39], v[76:77] op_sel:[1,1,0] op_sel_hi:[0,1,1] neg_lo:[1,0,0]
  v_pk_fma_f32 v[78:79], v[74:75], v[38:39], v[78:79] op_sel:[1,1,0] op_sel_hi:[0,1,1] neg_lo:[1,0,0]
  v_pk_mul_f32 v[30:31], v[48:49], v[44:45] op_sel:[0,0] op_sel_hi:[1,0]
  v_pk_fma_f32 v[30:31], v[48:49], v[44:45], v[30:31] op_sel:[1,1,0] op_sel_hi:[0,1,1] neg_lo:[1,0,0]
  v_mfma_f32_32x32x16_bf16 v[128:143], v[104:107], v[96:99], 0
  v_cvt_pk_bf16_f32 v112, v48, v48
  v_cvt_pk_bf16_f32 v113, v72, v74
  v_cvt_pk_bf16_f32 v114, v74, v74
  v_cvt_pk_bf16_f32 v115, v76, v78
  v_cvt_pk_bf16_f32 v116, -v49, -v49
  v_cvt_pk_bf16_f32 v117, -v73, -v75
  v_mfma_f32_32x32x16_bf16 v[144:159], v[108:111], v[96:99], 0
  v_cvt_pk_bf16_f32 v118, -v75, -v75
  v_cvt_pk_bf16_f32 v119, -v77, -v79
  v_cvt_pk_bf16_f32 v208, v160, v176
  v_cvt_pk_bf16_f32 v209, v161, v177
  v_cvt_pk_bf16_f32 v210, v162, v178
  v_cvt_pk_bf16_f32 v211, v163, v179
  v_cvt_pk_bf16_f32 v212, v164, v180
  v_cvt_pk_bf16_f32 v213, v165, v181
  v_cvt_pk_bf16_f32 v214, v166, v182
  v_cvt_pk_bf16_f32 v215, v167, v183
  v_pk_mul_f32 v[32:33], v[30:31], v[44:45] op_sel:[0,0] op_sel_hi:[1,0]
  v_pk_mul_f32 v[72:73], v[30:31], v[38:39] op_sel:[0,0] op_sel_hi:[1,0]
  v_pk_fma_f32 v[32:33], v[30:31], v[44:45], v[32:33] op_sel:[1,1,0] op_sel_hi:[0,1,1] neg_lo:[1,0,0]
  v_pk_fma_f32 v[72:73], v[30:31], v[38:39], v[72:73] op_sel:[1,1,0] op_sel_hi:[0,1,1] neg_lo:[1,0,0]
  v_pk_mul_f32 v[74:75], v[30:31], v[40:41] op_sel:[0,0] op_sel_hi:[1,0]
  v_pk_mul_f32 v[76:77], v[32:33], v[38:39] op_sel:[0,0] op_sel_hi:[1,0]
  v_pk_fma_f32 v[74:75], v[30:31], v[40:41], v[74:75] op_sel:[1,1,0] op_sel_hi:[0,1,1] neg_lo:[1,0,0]
  v_pk_fma_f32 v[76:77], v[32:33], v[38:39], v[76:77] op_sel:[1,1,0] op_sel_hi:[0,1,1] neg_lo:[1,0,0]
  v_pk_mul_f32 v[46:47], v[32:33], v[44:45] op_sel:[0,0] op_sel_hi:[1,0]
  v_pk_mul_f32 v[78:79], v[32:33], v[40:41] op_sel:[0,0] op_sel_hi:[1,0]
  v_pk_fma_f32 v[46:47], v[32:33], v[44:45], v[46:47] op_sel:[1,1,0] op_sel_hi:[0,1,1] neg_lo:[1,0,0]
  v_pk_fma_f32 v[78:79], v[32:33], v[40:41], v[78:79] op_sel:[1,1,0] op_sel_hi:[0,1,1] neg_lo:[1,0,0]
  v_mfma_f32_32x32x16_bf16 v[128:143], v[112:115], v[100:103], v[128:143]
  v_cvt_pk_bf16_f32 v104, v30, v72
  v_cvt_pk_bf16_f32 v105, v74, v74
  v_cvt_pk_bf16_f32 v106, v32, v76
  v_cvt_pk_bf16_f32 v107, v78, v78
  v_cvt_pk_bf16_f32 v108, -v31, -v73
  v_cvt_pk_bf16_f32 v109, -v75, -v75
  v_mfma_f32_32x32x16_bf16 v[144:159], v[116:119], v[100:103], v[144:159]
  v_cvt_pk_bf16_f32 v110, -v33, -v77
  v_cvt_pk_bf16_f32 v111, -v79, -v79
  v_cvt_pk_bf16_f32 v216, v168, v184
  v_cvt_pk_bf16_f32 v217, v169, v185
  v_cvt_pk_bf16_f32 v218, v170, v186
  v_cvt_pk_bf16_f32 v219, v171, v187
  v_cvt_pk_bf16_f32 v220, v172, v188
  v_cvt_pk_bf16_f32 v221, v173, v189
  v_cvt_pk_bf16_f32 v222, v174, v190
  v_cvt_pk_bf16_f32 v223, v175, v191
  s_and_b32 s29, s3, 1
  v_mov_b32 v240, 0
  v_mov_b32 v241, 0
  v_mov_b32 v242, 0
  v_mov_b32 v243, 0
  s_lshl_b32 s63, s28, 4
  s_lshr_b32 s63, s31, s63
  s_lshl_b32 s63, s63, 16
  s_cmp_eq_u32 s29, 0
  s_cselect_b32 s63, s63, 0
  s_mov_b64 exec, 1
  v_mov_b32 v240, s63
  s_mov_b64 exec, -1
  v_pk_mul_f32 v[74:75], v[46:47], v[44:45] op_sel:[0,0] op_sel_hi:[1,0]
  v_pk_mul_f32 v[120:121], v[46:47], v[40:41] op_sel:[0,0] op_sel_hi:[1,0]
  v_pk_fma_f32 v[74:75], v[46:47], v[44:45], v[74:75] op_sel:[1,1,0] op_sel_hi:[0,1,1] neg_lo:[1,0,0]
  v_pk_fma_f32 v[120:121], v[46:47], v[40:41], v[120:121] op_sel:[1,1,0] op_sel_hi:[0,1,1] neg_lo:[1,0,0]
  v_pk_mul_f32 v[76:77], v[74:75], v[44:45] op_sel:[0,0] op_sel_hi:[1,0]
  v_pk_mul_f32 v[122:123], v[74:75], v[40:41] op_sel:[0,0] op_sel_hi:[1,0]
  v_pk_fma_f32 v[76:77], v[74:75], v[44:45], v[76:77] op_sel:[1,1,0] op_sel_hi:[0,1,1] neg_lo:[1,0,0]
  v_pk_fma_f32 v[122:123], v[74:75], v[40:41], v[122:123] op_sel:[1,1,0] op_sel_hi:[0,1,1] neg_lo:[1,0,0]
  v_pk_mul_f32 v[78:79], v[76:77], v[44:45] op_sel:[0,0] op_sel_hi:[1,0]
  v_pk_mul_f32 v[124:125], v[76:77], v[40:41] op_sel:[0,0] op_sel_hi:[1,0]
  v_pk_fma_f32 v[78:79], v[76:77], v[44:45], v[78:79] op_sel:[1,1,0] op_sel_hi:[0,1,1] neg_lo:[1,0,0]
  v_pk_fma_f32 v[124:125], v[76:77], v[40:41], v[124:125] op_sel:[1,1,0] op_sel_hi:[0,1,1] neg_lo:[1,0,0]
  v_pk_mul_f32 v[126:127], v[78:79], v[40:41] op_sel:[0,0] op_sel_hi:[1,0]
  v_pk_fma_f32 v[126:127], v[78:79], v[40:41], v[126:127] op_sel:[1,1,0] op_sel_hi:[0,1,1] neg_lo:[1,0,0]
  v_mfma_f32_32x32x16_bf16 v[160:175], v[104:107], v[96:99], 0
  v_cvt_pk_bf16_f32 v112, v46, v120
  v_cvt_pk_bf16_f32 v113, v74, v122
  v_cvt_pk_bf16_f32 v114, v76, v124
  v_cvt_pk_bf16_f32 v115, v78, v126
  v_cvt_pk_bf16_f32 v116, -v47, -v121
  v_cvt_pk_bf16_f32 v117, -v75, -v123
  v_mfma_f32_32x32x16_bf16 v[176:191], v[108:111], v[96:99], 0
  v_cvt_pk_bf16_f32 v118, -v77, -v125
  v_cvt_pk_bf16_f32 v119, -v79, -v127
  v_cvt_pk_bf16_f32 v224, v128, v144
  v_cvt_pk_bf16_f32 v225, v129, v145
  v_cvt_pk_bf16_f32 v226, v130, v146
  v_cvt_pk_bf16_f32 v227, v131, v147
  v_cvt_pk_bf16_f32 v228, v132, v148
  v_cvt_pk_bf16_f32 v229, v133, v149
  v_cvt_pk_bf16_f32 v230, v134, v150
  v_cvt_pk_bf16_f32 v231, v135, v151
  v_pk_mul_f32 v[64:65], v[62:63], v[62:63] op_sel:[0,0] op_sel_hi:[1,0]
  v_pk_fma_f32 v[64:65], v[62:63], v[62:63], v[64:65] op_sel:[1,1,0] op_sel_hi:[0,1,1] neg_lo:[1,0,0]
  v_pk_mul_f32 v[122:123], v[62:63], v[64:65] op_sel:[0,0] op_sel_hi:[1,0]
  v_pk_fma_f32 v[122:123], v[62:63], v[64:65], v[122:123] op_sel:[1,1,0] op_sel_hi:[0,1,1] neg_lo:[1,0,0]
  v_pk_mul_f32 v[76:77], v[64:65], v[64:65] op_sel:[0,0] op_sel_hi:[1,0]
  v_pk_mul_f32 v[124:125], v[122:123], v[64:65] op_sel:[0,0] op_sel_hi:[1,0]
  v_pk_fma_f32 v[76:77], v[64:65], v[64:65], v[76:77] op_sel:[1,1,0] op_sel_hi:[0,1,1] neg_lo:[1,0,0]
  v_pk_fma_f32 v[124:125], v[122:123], v[64:65], v[124:125] op_sel:[1,1,0] op_sel_hi:[0,1,1] neg_lo:[1,0,0]
  v_pk_mul_f32 v[78:79], v[76:77], v[64:65] op_sel:[0,0] op_sel_hi:[1,0]
  v_pk_mul_f32 v[126:127], v[124:125], v[64:65] op_sel:[0,0] op_sel_hi:[1,0]
  v_pk_fma_f32 v[78:79], v[76:77], v[64:65], v[78:79] op_sel:[1,1,0] op_sel_hi:[0,1,1] neg_lo:[1,0,0]
  v_pk_fma_f32 v[126:127], v[124:125], v[64:65], v[126:127] op_sel:[1,1,0] op_sel_hi:[0,1,1] neg_lo:[1,0,0]
  v_mfma_f32_32x32x16_bf16 v[160:175], v[112:115], v[100:103], v[160:175]
  v_mul_f32 v70, 0x43800000, v50
  v_exp_f32 v68, v50
  v_mul_f32 v71, 0x43800000, v51
  v_fract_f32 v69, v51
  v_exp_f32 v70, v70
  v_cos_f32 v56, v69
  v_mfma_f32_32x32x16_bf16 v[176:191], v[116:119], v[100:103], v[176:191]
  v_fract_f32 v71, v71
  v_cvt_pk_bf16_f32 v104, 1.0, v62
  v_cvt_pk_bf16_f32 v105, v64, v122
  v_cvt_pk_bf16_f32 v106, v76, v124
  v_cvt_pk_bf16_f32 v107, v78, v126
  v_cvt_pk_bf16_f32 v108, 0, v63
  v_mfma_f32_16x16x32_bf16 v[240:243], v[224:227], v[192:195], v[240:243]
  v_cvt_pk_bf16_f32 v109, v65, v123
  v_cvt_pk_bf16_f32 v110, v77, v125
  v_cvt_pk_bf16_f32 v111, v79, v127
  v_mfma_f32_16x16x32_bf16 v[248:251], v[224:227], v[208:211], 0
  v_cvt_pk_bf16_f32 v232, v136, v152
  v_cvt_pk_bf16_f32 v233, v137, v153
  v_cvt_pk_bf16_f32 v234, v138, v154
  v_mfma_f32_16x16x32_bf16 v[240:243], v[228:231], v[196:199], v[240:243]
  v_cvt_pk_bf16_f32 v235, v139, v155
  v_cvt_pk_bf16_f32 v236, v140, v156
  v_cvt_pk_bf16_f32 v237, v141, v157
  v_mfma_f32_16x16x32_bf16 v[248:251], v[228:231], v[212:215], v[248:251]
  v_cvt_pk_bf16_f32 v238, v142, v158
  v_cvt_pk_bf16_f32 v239, v143, v159
  v_pk_mul_f32 v[72:73], v[78:79], v[64:65] op_sel:[0,0] op_sel_hi:[1,0]
  v_pk_mul_f32 v[120:121], v[126:127], v[64:65] op_sel:[0,0] op_sel_hi:[1,0]
  v_pk_fma_f32 v[72:73], v[78:79], v[64:65], v[72:73] op_sel:[1,1,0] op_sel_hi:[0,1,1] neg_lo:[1,0,0]
  v_pk_fma_f32 v[120:121], v[126:127], v[64:65], v[120:121] op_sel:[1,1,0] op_sel_hi:[0,1,1] neg_lo:[1,0,0]
  v_pk_mul_f32 v[74:75], v[72:73], v[64:65] op_sel:[0,0] op_sel_hi:[1,0]
  v_pk_mul_f32 v[122:123], v[120:121], v[64:65] op_sel:[0,0] op_sel_hi:[1,0]
  v_pk_fma_f32 v[74:75], v[72:73], v[64:65], v[74:75] op_sel:[1,1,0] op_sel_hi:[0,1,1] neg_lo:[1,0,0]
  v_pk_fma_f32 v[122:123], v[120:121], v[64:65], v[122:123] op_sel:[1,1,0] op_sel_hi:[0,1,1] neg_lo:[1,0,0]
  v_pk_mul_f32 v[76:77], v[74:75], v[64:65] op_sel:[0,0] op_sel_hi:[1,0]
  v_pk_mul_f32 v[124:125], v[122:123], v[64:65] op_sel:[0,0] op_sel_hi:[1,0]
  v_pk_fma_f32 v[76:77], v[74:75], v[64:65], v[76:77] op_sel:[1,1,0] op_sel_hi:[0,1,1] neg_lo:[1,0,0]
  v_pk_fma_f32 v[124:125], v[122:123], v[64:65], v[124:125] op_sel:[1,1,0] op_sel_hi:[0,1,1] neg_lo:[1,0,0]
  v_pk_mul_f32 v[78:79], v[76:77], v[64:65] op_sel:[0,0] op_sel_hi:[1,0]
  v_pk_mul_f32 v[126:127], v[124:125], v[64:65] op_sel:[0,0] op_sel_hi:[1,0]
  v_pk_fma_f32 v[78:79], v[76:77], v[64:65], v[78:79] op_sel:[1,1,0] op_sel_hi:[0,1,1] neg_lo:[1,0,0]
  v_pk_fma_f32 v[126:127], v[124:125], v[64:65], v[126:127] op_sel:[1,1,0] op_sel_hi:[0,1,1] neg_lo:[1,0,0]
  v_mfma_f32_32x32x16_bf16 v[128:143], v[104:107], v[96:99], 0
  v_sin_f32 v57, v69
  v_cos_f32 v66, v71
  v_mul_f32 v56, v56, v68
  v_sin_f32 v67, v71
  v_mul_f32 v57, v57, v68
  v_mul_f32 v66, v66, v70
  v_mfma_f32_32x32x16_bf16 v[144:159], v[108:111], v[96:99], 0
  v_mul_f32 v67, v67, v70
  v_cvt_pk_bf16_f32 v112, v72, v120
  v_cvt_pk_bf16_f32 v113, v74, v122
  v_cvt_pk_bf16_f32 v114, v76, v124
  v_cvt_pk_bf16_f32 v115, v78, v126
  v_cvt_pk_bf16_f32 v116, v73, v121
  v_mfma_f32_16x16x32_bf16 v[240:243], v[232:235], v[200:203], v[240:243]
  v_cvt_pk_bf16_f32 v117, v75, v123
  v_cvt_pk_bf16_f32 v118, v77, v125
  v_cvt_pk_bf16_f32 v119, v79, v127
  v_mfma_f32_16x16x32_bf16 v[248:251], v[232:235], v[216:219], v[248:251]
  v_cvt_pk_bf16_f32 v224, v160, v176
  v_cvt_pk_bf16_f32 v225, v161, v177
  v_cvt_pk_bf16_f32 v226, v162, v178
  v_mfma_f32_16x16x32_bf16 v[240:243], v[236:239], v[204:207], v[240:243]
  v_cvt_pk_bf16_f32 v227, v163, v179
  v_cvt_pk_bf16_f32 v228, v164, v180
  v_cvt_pk_bf16_f32 v229, v165, v181
  v_mfma_f32_16x16x32_bf16 v[248:251], v[236:239], v[220:223], v[248:251]
  v_cvt_pk_bf16_f32 v230, v166, v182
  v_cvt_pk_bf16_f32 v231, v167, v183
  v_pk_mul_f32 v[72:73], v[78:79], v[64:65] op_sel:[0,0] op_sel_hi:[1,0]
  v_pk_mul_f32 v[120:121], v[126:127], v[64:65] op_sel:[0,0] op_sel_hi:[1,0]
  v_pk_fma_f32 v[72:73], v[78:79], v[64:65], v[72:73] op_sel:[1,1,0] op_sel_hi:[0,1,1] neg_lo:[1,0,0]
  v_pk_fma_f32 v[120:121], v[126:127], v[64:65], v[120:121] op_sel:[1,1,0] op_sel_hi:[0,1,1] neg_lo:[1,0,0]
  v_pk_mul_f32 v[74:75], v[72:73], v[64:65] op_sel:[0,0] op_sel_hi:[1,0]
  v_pk_mul_f32 v[122:123], v[120:121], v[64:65] op_sel:[0,0] op_sel_hi:[1,0]
  v_pk_fma_f32 v[74:75], v[72:73], v[64:65], v[74:75] op_sel:[1,1,0] op_sel_hi:[0,1,1] neg_lo:[1,0,0]
  v_pk_fma_f32 v[122:123], v[120:121], v[64:65], v[122:123] op_sel:[1,1,0] op_sel_hi:[0,1,1] neg_lo:[1,0,0]
  v_pk_mul_f32 v[76:77], v[74:75], v[64:65] op_sel:[0,0] op_sel_hi:[1,0]
  v_pk_mul_f32 v[124:125], v[122:123], v[64:65] op_sel:[0,0] op_sel_hi:[1,0]
  v_pk_fma_f32 v[76:77], v[74:75], v[64:65], v[76:77] op_sel:[1,1,0] op_sel_hi:[0,1,1] neg_lo:[1,0,0]
  v_pk_fma_f32 v[124:125], v[122:123], v[64:65], v[124:125] op_sel:[1,1,0] op_sel_hi:[0,1,1] neg_lo:[1,0,0]
  v_pk_mul_f32 v[78:79], v[76:77], v[64:65] op_sel:[0,0] op_sel_hi:[1,0]
  v_pk_mul_f32 v[126:127], v[124:125], v[64:65] op_sel:[0,0] op_sel_hi:[1,0]
  v_pk_fma_f32 v[78:79], v[76:77], v[64:65], v[78:79] op_sel:[1,1,0] op_sel_hi:[0,1,1] neg_lo:[1,0,0]
  v_pk_fma_f32 v[126:127], v[124:125], v[64:65], v[126:127] op_sel:[1,1,0] op_sel_hi:[0,1,1] neg_lo:[1,0,0]
  v_mfma_f32_32x32x16_bf16 v[128:143], v[112:115], v[100:103], v[128:143]
  v_and_b32 v52, 0xffff0000, v22
  v_and_b32 v53, 0xffff0000, v23
  v_and_b32 v54, 0xffff0000, v24
  v_and_b32 v55, 0xffff0000, v25
  v_mul_f32 v52, v26, v52
  v_mul_f32 v53, v26, v53
  v_mfma_f32_32x32x16_bf16 v[144:159], v[116:119], v[100:103], v[144:159]
  v_cvt_pk_bf16_f32 v104, v72, v120
  v_cvt_pk_bf16_f32 v105, v74, v122
  v_cvt_pk_bf16_f32 v106, v76, v124
  v_cvt_pk_bf16_f32 v107, v78, v126
  v_cvt_pk_bf16_f32 v108, v73, v121
  v_cvt_pk_bf16_f32 v109, v75, v123
  v_mfma_f32_16x16x32_bf16 v[244:247], v[224:227], v[192:195], 0
  v_cvt_pk_bf16_f32 v110, v77, v125
  v_cvt_pk_bf16_f32 v111, v79, v127
  v_cvt_pk_bf16_f32 v232, v168, v184
  v_mfma_f32_16x16x32_bf16 v[252:255], v[224:227], v[208:211], 0
  v_cvt_pk_bf16_f32 v233, v169, v185
  v_cvt_pk_bf16_f32 v234, v170, v186
  v_cvt_pk_bf16_f32 v235, v171, v187
  v_mfma_f32_16x16x32_bf16 v[244:247], v[228:231], v[196:199], v[244:247]
  v_cvt_pk_bf16_f32 v236, v172, v188
  s_branch Lpg_P4
Lh_P4:
  s_branch La_t
Lpg_P4:
  v_cvt_pk_bf16_f32 v237, v173, v189
  v_cvt_pk_bf16_f32 v238, v174, v190
  v_mfma_f32_16x16x32_bf16 v[252:255], v[228:231], v[212:215], v[252:255]
  v_cvt_pk_bf16_f32 v239, v175, v191
  v_pk_mul_f32 v[68:69], v[54:55], v[52:53] op_sel:[0,0] op_sel_hi:[1,0]
  v_pk_fma_f32 v[68:69], v[54:55], v[52:53], v[68:69] op_sel:[1,1,0] op_sel_hi:[0,1,1] neg_lo:[1,0,0]
  v_pk_mul_f32 v[58:59], v[56:57], v[56:57] op_sel:[0,0] op_sel_hi:[1,0]
  v_pk_fma_f32 v[58:59], v[56:57], v[56:57], v[58:59] op_sel:[1,1,0] op_sel_hi:[0,1,1] neg_lo:[1,0,0]
  v_pk_mul_f32 v[60:61], v[58:59], v[58:59] op_sel:[0,0] op_sel_hi:[1,0]
  v_pk_fma_f32 v[60:61], v[58:59], v[58:59], v[60:61] op_sel:[1,1,0] op_sel_hi:[0,1,1] neg_lo:[1,0,0]
  v_pk_mul_f32 v[72:73], v[78:79], v[64:65] op_sel:[0,0] op_sel_hi:[1,0]
  v_pk_mul_f32 v[120:121], v[126:127], v[64:65] op_sel:[0,0] op_sel_hi:[1,0]
  v_pk_fma_f32 v[72:73], v[78:79], v[64:65], v[72:73] op_sel:[1,1,0] op_sel_hi:[0,1,1] neg_lo:[1,0,0]
  v_pk_fma_f32 v[120:121], v[126:127], v[64:65], v[120:121] op_sel:[1,1,0] op_sel_hi:[0,1,1] neg_lo:[1,0,0]
  v_pk_mul_f32 v[74:75], v[72:73], v[64:65] op_sel:[0,0] op_sel_hi:[1,0]
  v_pk_mul_f32 v[122:123], v[120:121], v[64:65] op_sel:[0,0] op_sel_hi:[1,0]
  v_pk_fma_f32 v[74:75], v[72:73], v[64:65], v[74:75] op_sel:[1,1,0] op_sel_hi:[0,1,1] neg_lo:[1,0,0]
  v_pk_fma_f32 v[122:123], v[120:121], v[64:65], v[122:123] op_sel:[1,1,0] op_sel_hi:[0,1,1] neg_lo:[1,0,0]
  v_pk_mul_f32 v[76:77], v[74:75], v[64:65] op_sel:[0,0] op_sel_hi:[1,0]
  v_pk_mul_f32 v[124:125], v[122:123], v[64:65] op_sel:[0,0] op_sel_hi:[1,0]
  v_pk_fma_f32 v[76:77], v[74:75], v[64:65], v[76:77] op_sel:[1,1,0] op_sel_hi:[0,1,1] neg_lo:[1,0,0]
  v_pk_fma_f32 v[124:125], v[122:123], v[64:65], v[124:125] op_sel:[1,1,0] op_sel_hi:[0,1,1] neg_lo:[1,0,0]
  v_pk_mul_f32 v[78:79], v[76:77], v[64:65] op_sel:[0,0] op_sel_hi:[1,0]
  v_pk_mul_f32 v[126:127], v[124:125], v[64:65] op_sel:[0,0] op_sel_hi:[1,0]
  v_pk_fma_f32 v[78:79], v[76:77], v[64:65], v[78:79] op_sel:[1,1,0] op_sel_hi:[0,1,1] neg_lo:[1,0,0]
  v_pk_fma_f32 v[126:127], v[124:125], v[64:65], v[126:127] op_sel:[1,1,0] op_sel_hi:[0,1,1] neg_lo:[1,0,0]
  v_mfma_f32_32x32x16_bf16 v[160:175], v[104:107], v[96:99], 0
  v_cvt_pk_bf16_f32 v112, v72, v120
  v_cvt_pk_bf16_f32 v113, v74, v122
  v_cvt_pk_bf16_f32 v114, v76, v124
  v_cvt_pk_bf16_f32 v115, v78, v126
  v_cvt_pk_bf16_f32 v116, v73, v121
  v_cvt_pk_bf16_f32 v117, v75, v123
  v_mfma_f32_32x32x16_bf16 v[176:191], v[108:111], v[96:99], 0
  v_cvt_pk_bf16_f32 v118, v77, v125
  v_cvt_pk_bf16_f32 v119, v79, v127
  v_cvt_pk_bf16_f32 v192, v128, v144
  v_cvt_pk_bf16_f32 v193, v129, v145
  v_cvt_pk_bf16_f32 v194, v130, v146
  v_cvt_pk_bf16_f32 v195, v131, v147
  v_mfma_f32_16x16x32_bf16 v[244:247], v[232:235], v[200:203], v[244:247]
  v_cvt_pk_bf16_f32 v196, v132, v148
  v_cvt_pk_bf16_f32 v197, v133, v149
  v_cvt_pk_bf16_f32 v198, v134, v150
  v_mfma_f32_16x16x32_bf16 v[252:255], v[232:235], v[216:219], v[252:255]
  v_cvt_pk_bf16_f32 v199, v135, v151
  v_mfma_f32_16x16x32_bf16 v[244:247], v[236:239], v[204:207], v[244:247]
  v_mfma_f32_16x16x32_bf16 v[252:255], v[236:239], v[220:223], v[252:255]
  v_pk_mul_f32 v[120:121], v[68:69], v[56:57] op_sel:[0,0] op_sel_hi:[1,0]
  v_pk_mul_f32 v[74:75], v[68:69], v[58:59] op_sel:[0,0] op_sel_hi:[1,0]
  v_pk_fma_f32 v[120:121], v[68:69], v[56:57], v[120:121] op_sel:[1,1,0] op_sel_hi:[0,1,1] neg_lo:[1,0,0]
  v_pk_fma_f32 v[74:75], v[68:69], v[58:59], v[74:75] op_sel:[1,1,0] op_sel_hi:[0,1,1] neg_lo:[1,0,0]
  v_pk_mul_f32 v[122:123], v[120:121], v[58:59] op_sel:[0,0] op_sel_hi:[1,0]
  v_pk_mul_f32 v[76:77], v[74:75], v[58:59] op_sel:[0,0] op_sel_hi:[1,0]
  v_pk_fma_f32 v[122:123], v[120:121], v[58:59], v[122:123] op_sel:[1,1,0] op_sel_hi:[0,1,1] neg_lo:[1,0,0]
  v_pk_fma_f32 v[76:77], v[74:75], v[58:59], v[76:77] op_sel:[1,1,0] op_sel_hi:[0,1,1] neg_lo:[1,0,0]
  v_pk_mul_f32 v[124:125], v[122:123], v[58:59] op_sel:[0,0] op_sel_hi:[1,0]
  v_pk_mul_f32 v[78:79], v[76:77], v[58:59] op_sel:[0,0] op_sel_hi:[1,0]
  v_pk_fma_f32 v[124:125], v[122:123], v[58:59], v[124:125] op_sel:[1,1,0] op_sel_hi:[0,1,1] neg_lo:[1,0,0]
  v_pk_fma_f32 v[78:79], v[76:77], v[58:59], v[78:79] op_sel:[1,1,0] op_sel_hi:[0,1,1] neg_lo:[1,0,0]
  v_pk_mul_f32 v[126:127], v[124:125], v[58:59] op_sel:[0,0] op_sel_hi:[1,0]
  v_pk_mul_f32 v[70:71], v[68:69], v[66:67] op_sel:[0,0] op_sel_hi:[1,0]
  v_pk_fma_f32 v[126:127], v[124:125], v[58:59], v[126:127] op_sel:[1,1,0] op_sel_hi:[0,1,1] neg_lo:[1,0,0]
  v_pk_fma_f32 v[70:71], v[68:69], v[66:67], v[70:71] op_sel:[1,1,0] op_sel_hi:[0,1,1] neg_lo:[1,0,0]
  v_mfma_f32_32x32x16_bf16 v[160:175], v[112:115], v[100:103], v[160:175]
  v_cvt_pk_bf16_f32 v104, v68, v120
  v_cvt_pk_bf16_f32 v105, v74, v122
  v_cvt_pk_bf16_f32 v106, v76, v124
  v_cvt_pk_bf16_f32 v107, v78, v126
  v_cvt_pk_bf16_f32 v108, -v69, -v121
  v_cvt_pk_bf16_f32 v109, -v75, -v123
  v_mfma_f32_32x32x16_bf16 v[176:191], v[116:119], v[100:103], v[176:191]
  v_cvt_pk_bf16_f32 v110, -v77, -v125
  v_cvt_pk_bf16_f32 v111, -v79, -v127
  v_cvt_pk_bf16_f32 v200, v136, v152
  v_cvt_pk_bf16_f32 v201, v137, v153
  v_cvt_pk_bf16_f32 v202, v138, v154
  v_cvt_pk_bf16_f32 v203, v139, v155
  v_cvt_pk_bf16_f32 v204, v140, v156
  v_cvt_pk_bf16_f32 v205, v141, v157
  v_cvt_pk_bf16_f32 v206, v142, v158
  v_cvt_pk_bf16_f32 v207, v143, v159
  v_pk_mul_f32 v[72:73], v[70:71], v[58:59] op_sel:[0,0] op_sel_hi:[1,0]
  v_pk_mul_f32 v[74:75], v[70:71], v[60:61] op_sel:[0,0] op_sel_hi:[1,0]
  v_pk_fma_f32 v[72:73], v[70:71], v[58:59], v[72:73] op_sel:[1,1,0] op_sel_hi:[0,1,1] neg_lo:[1,0,0]
  v_pk_fma_f32 v[74:75], v[70:71], v[60:61], v[74:75] op_sel:[1,1,0] op_sel_hi:[0,1,1] neg_lo:[1,0,0]
  v_pk_mul_f32 v[76:77], v[72:73], v[60:61] op_sel:[0,0] op_sel_hi:[1,0]
  v_pk_mul_f32 v[78:79], v[74:75], v[60:61] op_sel:[0,0] op_sel_hi:[1,0]
  v_pk_fma_f32 v[76:77], v[72:73], v[60:61], v[76:77] op_sel:[1,1,0] op_sel_hi:[0,1,1] neg_lo:[1,0,0]
  v_pk_fma_f32 v[78:79], v[74:75], v[60:61], v[78:79] op_sel:[1,1,0] op_sel_hi:[0,1,1] neg_lo:[1,0,0]
  v_pk_mul_f32 v[52:53], v[70:71], v[66:67] op_sel:[0,0] op_sel_hi:[1,0]
  v_pk_fma_f32 v[52:53], v[70:71], v[66:67], v[52:53] op_sel:[1,1,0] op_sel_hi:[0,1,1] neg_lo:[1,0,0]
  v_mfma_f32_32x32x16_bf16 v[128:143], v[104:107], v[96:99], 0
  v_cvt_pk_bf16_f32 v112, v70, v70
  v_cvt_pk_bf16_f32 v113, v72, v74
  v_cvt_pk_bf16_f32 v114, v74, v74
  v_cvt_pk_bf16_f32 v115, v76, v78
  v_cvt_pk_bf16_f32 v116, -v71, -v71
  v_cvt_pk_bf16_f32 v117, -v73, -v75
  v_mfma_f32_32x32x16_bf16 v[144:159], v[108:111], v[96:99], 0
  v_cvt_pk_bf16_f32 v118, -v75, -v75
  v_cvt_pk_bf16_f32 v119, -v77, -v79
  v_cvt_pk_bf16_f32 v208, v160, v176
  v_cvt_pk_bf16_f32 v209, v161, v177
  v_cvt_pk_bf16_f32 v210, v162, v178
  v_cvt_pk_bf16_f32 v211, v163, v179
  v_cvt_pk_bf16_f32 v212, v164, v180
  v_cvt_pk_bf16_f32 v213, v165, v181
  v_cvt_pk_bf16_f32 v214, v166, v182
  v_cvt_pk_bf16_f32 v215, v167, v183
  v_pk_mul_f32 v[54:55], v[52:53], v[66:67] op_sel:[0,0] op_sel_hi:[1,0]
  v_pk_mul_f32 v[72:73], v[52:53], v[60:61] op_sel:[0,0] op_sel_hi:[1,0]
  v_pk_fma_f32 v[54:55], v[52:53], v[66:67], v[54:55] op_sel:[1,1,0] op_sel_hi:[0,1,1] neg_lo:[1,0,0]
  v_pk_fma_f32 v[72:73], v[52:53], v[60:61], v[72:73] op_sel:[1,1,0] op_sel_hi:[0,1,1] neg_lo:[1,0,0]
  v_pk_mul_f32 v[74:75], v[52:53], v[62:63] op_sel:[0,0] op_sel_hi:[1,0]
  v_pk_mul_f32 v[76:77], v[54:55], v[60:61] op_sel:[0,0] op_sel_hi:[1,0]
  v_pk_fma_f32 v[74:75], v[52:53], v[62:63], v[74:75] op_sel:[1,1,0] op_sel_hi:[0,1,1] neg_lo:[1,0,0]
  v_pk_fma_f32 v[76:77], v[54:55], v[60:61], v[76:77] op_sel:[1,1,0] op_sel_hi:[0,1,1] neg_lo:[1,0,0]
  v_pk_mul_f32 v[68:69], v[54:55], v[66:67] op_sel:[0,0] op_sel_hi:[1,0]
  v_pk_mul_f32 v[78:79], v[54:55], v[62:63] op_sel:[0,0] op_sel_hi:[1,0]
  v_pk_fma_f32 v[68:69], v[54:55], v[66:67], v[68:69] op_sel:[1,1,0] op_sel_hi:[0,1,1] neg_lo:[1,0,0]
  v_pk_fma_f32 v[78:79], v[54:55], v[62:63], v[78:79] op_sel:[1,1,0] op_sel_hi:[0,1,1] neg_lo:[1,0,0]
  v_mfma_f32_32x32x16_bf16 v[128:143], v[112:115], v[100:103], v[128:143]
  v_cvt_pk_bf16_f32 v104, v52, v72
  v_cvt_pk_bf16_f32 v105, v74, v74
  v_cvt_pk_bf16_f32 v106, v54, v76
  v_cvt_pk_bf16_f32 v107, v78, v78
  v_cvt_pk_bf16_f32 v108, -v53, -v73
  v_cvt_pk_bf16_f32 v109, -v75, -v75
  v_mfma_f32_32x32x16_bf16 v[144:159], v[116:119], v[100:103], v[144:159]
  v_cvt_pk_bf16_f32 v110, -v55, -v77
  v_cvt_pk_bf16_f32 v111, -v79, -v79
  v_cvt_pk_bf16_f32 v216, v168, v184
  v_cvt_pk_bf16_f32 v217, v169, v185
  v_cvt_pk_bf16_f32 v218, v170, v186
  v_cvt_pk_bf16_f32 v219, v171, v187
  v_cvt_pk_bf16_f32 v220, v172, v188
  v_cvt_pk_bf16_f32 v221, v173, v189
  v_cvt_pk_bf16_f32 v222, v174, v190
  v_cvt_pk_bf16_f32 v223, v175, v191
  v_pk_mul_f32 v[74:75], v[68:69], v[66:67] op_sel:[0,0] op_sel_hi:[1,0]
  v_pk_mul_f32 v[120:121], v[68:69], v[62:63] op_sel:[0,0] op_sel_hi:[1,0]
  v_pk_fma_f32 v[74:75], v[68:69], v[66:67], v[74:75] op_sel:[1,1,0] op_sel_hi:[0,1,1] neg_lo:[1,0,0]
  v_pk_fma_f32 v[120:121], v[68:69], v[62:63], v[120:121] op_sel:[1,1,0] op_sel_hi:[0,1,1] neg_lo:[1,0,0]
  v_pk_mul_f32 v[76:77], v[74:75], v[66:67] op_sel:[0,0] op_sel_hi:[1,0]
  v_pk_mul_f32 v[122:123], v[74:75], v[62:63] op_sel:[0,0] op_sel_hi:[1,0]
  v_pk_fma_f32 v[76:77], v[74:75], v[66:67], v[76:77] op_sel:[1,1,0] op_sel_hi:[0,1,1] neg_lo:[1,0,0]
  v_pk_fma_f32 v[122:123], v[74:75], v[62:63], v[122:123] op_sel:[1,1,0] op_sel_hi:[0,1,1] neg_lo:[1,0,0]
  v_pk_mul_f32 v[78:79], v[76:77], v[66:67] op_sel:[0,0] op_sel_hi:[1,0]
  v_pk_mul_f32 v[124:125], v[76:77], v[62:63] op_sel:[0,0] op_sel_hi:[1,0]
  v_pk_fma_f32 v[78:79], v[76:77], v[66:67], v[78:79] op_sel:[1,1,0] op_sel_hi:[0,1,1] neg_lo:[1,0,0]
  v_pk_fma_f32 v[124:125], v[76:77], v[62:63], v[124:125] op_sel:[1,1,0] op_sel_hi:[0,1,1] neg_lo:[1,0,0]
  v_pk_mul_f32 v[126:127], v[78:79], v[62:63] op_sel:[0,0] op_sel_hi:[1,0]
  v_pk_fma_f32 v[126:127], v[78:79], v[62:63], v[126:127] op_sel:[1,1,0] op_sel_hi:[0,1,1] neg_lo:[1,0,0]
  v_mfma_f32_32x32x16_bf16 v[160:175], v[104:107], v[96:99], 0
  v_cvt_pk_bf16_f32 v112, v68, v120
  v_cvt_pk_bf16_f32 v113, v74, v122
  v_cvt_pk_bf16_f32 v114, v76, v124
  v_cvt_pk_bf16_f32 v115, v78, v126
  v_cvt_pk_bf16_f32 v116, -v69, -v121
  v_cvt_pk_bf16_f32 v117, -v75, -v123
  v_mfma_f32_32x32x16_bf16 v[176:191], v[108:111], v[96:99], 0
  v_cvt_pk_bf16_f32 v118, -v77, -v125
  v_cvt_pk_bf16_f32 v119, -v79, -v127
  v_cvt_pk_bf16_f32 v224, v128, v144
  v_cvt_pk_bf16_f32 v225, v129, v145
  v_cvt_pk_bf16_f32 v226, v130, v146
  v_cvt_pk_bf16_f32 v227, v131, v147
  v_cvt_pk_bf16_f32 v228, v132, v148
  v_cvt_pk_bf16_f32 v229, v133, v149
  v_cvt_pk_bf16_f32 v230, v134, v150
  v_cvt_pk_bf16_f32 v231, v135, v151
  s_mul_i32 s67, s3, 8704
  s_add_u32 s67, s67, 106496
  v_lshlrev_b32 v14, 4, v0
  v_add_u32 v2, s67, v14
  s_mov_b32 s16, s60
  s_mov_b32 s17, s61
  s_mov_b32 s18, 16777216
  s_mov_b32 s19, 0x20000
  s_mul_i32 m0, s28, 32848
  v_mov_b32 v12, 1
  v_mov_b32 v17, 0
  v_mov_b32 v18, 0
  v_mov_b32 v19, 0
  s_waitcnt lgkmcnt(0)
  s_mul_i32 s62, s62, 0x9E3779B1
  s_add_u32 s62, s62, 0x7F4A7C15
  s_or_b32 s62, s62, 1
  v_mov_b32 v7, s62
  s_lshl_b32 s64, s29, 11
  v_add_u32 v80, s64, v2
  s_mul_i32 s63, s29, -17408
  s_add_u32 s63, s63, 8704
  v_add_u32 v8, s63, v80
  s_lshr_b32 s63, s68, 1
  s_mul_i32 s63, s63, 20608
  s_mul_i32 s51, s3, 5120
  s_add_u32 s51, s51, s63
  s_add_u32 s51, s51, 8388608
  v_lshrrev_b32 v1, 3, v0
  v_mul_u32_u24 v1, 640, v1
  s_and_b32 s63, s7, 1
  v_and_or_b32 v3, v0, 6, s63
  v_and_b32 v27, 1, v0
  v_lshl_add_u32 v3, v3, 1, v27
  v_lshl_add_u32 v87, v3, 4, v1
  v_lshl_add_u32 v86, v3, 3, v1
  v_lshl_add_u32 v4, s28, 4, v13
  v_mfma_f32_32x32x16_bf16 v[160:175], v[112:115], v[100:103], v[160:175]
  v_cvt_pk_bf16_f32 v232, v136, v152
  v_cvt_pk_bf16_f32 v233, v137, v153
  v_cvt_pk_bf16_f32 v234, v138, v154
  v_cvt_pk_bf16_f32 v235, v139, v155
  v_mfma_f32_32x32x16_bf16 v[176:191], v[116:119], v[100:103], v[176:191]
  v_cvt_pk_bf16_f32 v236, v140, v156
  v_cvt_pk_bf16_f32 v237, v141, v157
  v_cvt_pk_bf16_f32 v238, v142, v158
  v_cvt_pk_bf16_f32 v239, v143, v159
  v_mfma_f32_16x16x32_bf16 v[240:243], v[224:227], v[192:195], v[240:243]
  v_mfma_f32_16x16x32_bf16 v[248:251], v[224:227], v[208:211], v[248:251]
  v_mfma_f32_16x16x32_bf16 v[240:243], v[228:231], v[196:199], v[240:243]
  v_mfma_f32_16x16x32_bf16 v[248:251], v[228:231], v[212:215], v[248:251]
  v_mfma_f32_16x16x32_bf16 v[240:243], v[232:235], v[200:203], v[240:243]
  s_nop 2
  v_cvt_pk_bf16_f32 v32, v160, v176
  v_cvt_pk_bf16_f32 v33, v161, v177
  v_mfma_f32_16x16x32_bf16 v[248:251], v[232:235], v[216:219], v[248:251]
  v_cvt_pk_bf16_f32 v34, v162, v178
  v_cvt_pk_bf16_f32 v35, v163, v179
  v_mfma_f32_16x16x32_bf16 v[240:243], v[236:239], v[204:207], v[240:243]
  v_cvt_pk_bf16_f32 v36, v164, v180
  v_cvt_pk_bf16_f32 v37, v165, v181
  v_mfma_f32_16x16x32_bf16 v[248:251], v[236:239], v[220:223], v[248:251]
  v_cvt_pk_bf16_f32 v38, v166, v182
  v_cvt_pk_bf16_f32 v39, v167, v183
  v_mfma_f32_16x16x32_bf16 v[244:247], v[32:35], v[192:195], v[244:247]
  v_cvt_pk_bf16_f32 v40, v168, v184
  v_cvt_pk_bf16_f32 v41, v169, v185
  v_mfma_f32_16x16x32_bf16 v[252:255], v[32:35], v[208:211], v[252:255]
  v_cvt_pk_bf16_f32 v42, v170, v186
  v_cvt_pk_bf16_f32 v43, v171, v187
  v_mfma_f32_16x16x32_bf16 v[244:247], v[36:39], v[196:199], v[244:247]
  v_cvt_pk_bf16_f32 v44, v172, v188
  v_cvt_pk_bf16_f32 v45, v173, v189
  v_mfma_f32_16x16x32_bf16 v[252:255], v[36:39], v[212:215], v[252:255]
  v_cvt_pk_bf16_f32 v46, v174, v190
  v_cvt_pk_bf16_f32 v47, v175, v191
  v_mfma_f32_16x16x32_bf16 v[244:247], v[40:43], v[200:203], v[244:247]
  v_mfma_f32_16x16x32_bf16 v[252:255], v[40:43], v[216:219], v[252:255]
  v_mfma_f32_16x16x32_bf16 v[244:247], v[44:47], v[204:207], v[244:247]
  v_mfma_f32_16x16x32_bf16 v[252:255], v[44:47], v[220:223], v[252:255]
  ds_write_b128 v2, v[240:243] offset:0
  s_nop 5
  ds_write_b128 v2, v[244:247] offset:1024
  ds_write_b128 v2, v[248:251] offset:2048
  ds_write_b128 v2, v[252:255] offset:3072
  s_mov_b64 exec, 1
  ds_add_u32 v4, v12 offset:112
  s_mov_b64 exec, -1
  s_setprio 2
  ds_read_b128 v[240:243], v80 offset:0
  ds_read_b128 v[244:247], v80 offset:1024
  v_lshrrev_b32 v15, 5, v0
  s_mul_i32 s65, s28, 4544
  v_bfe_u32 v27, v0, 4, 1
  s_lshl_b32 s63, s29, 8
  s_add_u32 s63, s63, s65
  s_add_u32 s63, s63, 141760
  v_and_b32 v1, 15, v0
  v_lshl_add_u32 v1, v1, 4, s63
  v_lshl_add_u32 v85, v15, 9, v1
  v_lshl_add_u32 v85, v27, 3, v85
  v_lshlrev_b32 v3, v15, v27
  v_lshl_add_u32 v3, v15, 1, v3
  v_lshl_add_u32 v84, v3, 9, v1
  s_add_u32 s63, s65, 141248
  v_max_u32 v1, 8, v0
  v_lshl_add_u32 v1, v1, 3, s63
  ds_write_b64 v1, v[16:17]
  s_mul_i32 s64, s28, 4160
  s_add_u32 s64, s64, 150400
  v_and_or_b32 v3, v0, 60, s64
  ds_write_b32 v3, v16
  v_and_b32 v6, 3, v0
  v_lshl_add_u32 v6, v27, 2, v6
  v_bfe_u32 v27, v0, 2, 2
  s_add_u32 s63, s65, 141312
  v_add_u32 v82, v6, v15
  v_lshl_add_u32 v82, v82, 6, s63
  v_lshl_add_u32 v82, v27, 3, v82
  s_add_u32 s63, s64, 96
  v_lshl_add_u32 v83, v15, 3, v27
  v_sub_u32 v83, v6, v83
  v_lshl_add_u32 v83, v83, 3, s63
  v_and_b32 v6, 1, v0
  s_lshl_b32 s63, s3, 10
  s_add_u32 s63, s63, 150400
  v_mul_u32_u24 v6, 4144, v6
  v_add3_u32 v81, v6, v14, s63
  buffer_load_dwordx4 v[88:91], v87, s[16:19], s51 offen
  buffer_load_dwordx4 v[92:95], v87, s[16:19], s51 offen offset:256
  buffer_load_dwordx2 v[20:21], v86, s[16:19], s51 offen offset:512
  s_mov_b32 s64, 0
Lsp_22:
  ds_read_b32 v5, v4 offset:112
  s_add_u32 s64, s64, 1
  s_waitcnt lgkmcnt(0)
  v_readfirstlane_b32 s65, v5
  s_cmp_ge_u32 s65, 2
  s_cbranch_scc1 Lsx_23
  s_sleep 1
  s_cmp_lt_u32 s64, 200000
  s_cbranch_scc1 Lsp_22
Lsx_23:
  ds_read_b128 v[64:67], v8 offset:0
  ds_read_b128 v[68:71], v8 offset:1024
  s_mov_b32 s64, 0
  s_mov_b32 s65, 0x55555555
  s_mov_b32 vcc_lo, 0
  s_mov_b32 vcc_hi, -1
  s_waitcnt lgkmcnt(1)
  v_pk_add_f32 v[240:241], v[240:241], v[64:65]
  v_pk_add_f32 v[242:243], v[242:243], v[66:67]
  s_waitcnt lgkmcnt(0)
  v_pk_add_f32 v[244:245], v[244:245], v[68:69]
  v_pk_add_f32 v[246:247], v[246:247], v[70:71]
  v_cvt_pk_bf16_f32 v64, v240, v241
  v_cvt_pk_bf16_f32 v65, v242, v243
  v_cndmask_b32 v76, v245, v244, vcc
  v_cndmask_b32 v77, v245, v244, s[64:65]
  v_cndmask_b32 v78, v246, v245, vcc
  v_cndmask_b32 v79, v247, v246, s[64:65]
  ds_write_b64 v85, v[64:65]
  v_cvt_pk_bf16_f32 v68, v244, v244
  v_cvt_pk_bf16_f32 v69, v244, v76
  v_cvt_pk_bf16_f32 v70, v77, v245
  v_cvt_pk_bf16_f32 v71, v78, v78
  v_cvt_pk_bf16_f32 v72, v246, v246
  v_cvt_pk_bf16_f32 v73, v246, v246
  ds_write_b128 v84, v[68:71] offset:1024
  v_cvt_pk_bf16_f32 v74, v79, v247
  v_cvt_pk_bf16_f32 v75, v247, v247
  s_mov_b32 exec_lo, 0
  ds_write_b128 v84, v[72:75] offset:1536
  s_mov_b64 exec, -1
  s_mov_b32 s64, 0
  s_branch La_uc
La_ul:
  s_sleep 2
  buffer_load_dwordx4 v[88:91], v87, s[16:19], s51 offen sc1
  buffer_load_dwordx4 v[92:95], v87, s[16:19], s51 offen offset:256 sc1
  buffer_load_dwordx2 v[20:21], v86, s[16:19], s51 offen offset:512 sc1
La_uc:
  s_add_u32 s64, s64, 1
  s_waitcnt vmcnt(2)
  v_lshl_add_u32 v22, v88, 1, v89
  v_lshl_add_u32 v22, v22, 1, v90
  v_lshl_add_u32 v22, v22, 1, v91
  s_waitcnt vmcnt(0)
  v_bitop3_b32 v20, v20, v22, s62 bitop3:0x96
  v_lshl_add_u32 v23, v92, 1, v93
  v_lshl_add_u32 v23, v23, 1, v94
  v_lshl_add_u32 v23, v23, 1, v95
  v_bitop3_b32 v21, v21, v23, s62 bitop3:0x96
  v_or_b32 v20, v20, v21
  v_cmp_ne_u32 vcc, 0, v20
  s_cbranch_vccz La_ux
  s_cmp_lt_u32 s64, 12
  s_cbranch_scc1 La_ul
  s_branch La_ug
La_ux:
  ds_write_b128 v81, v[88:91] offset:64
  ds_write_b128 v81, v[92:95] offset:80
  s_mov_b64 exec, 1
  ds_add_u32 v13, v12 offset:144
  s_mov_b64 exec, -1
  s_mov_b32 s64, 0
Lsp_25:
  ds_read_b32 v5, v13 offset:144
  s_add_u32 s64, s64, 1
  s_waitcnt lgkmcnt(0)
  v_readfirstlane_b32 s65, v5
  s_cmp_ge_u32 s65, 4
  s_cbranch_scc1 Lsx_26
  s_sleep 1
  s_cmp_lt_u32 s64, 200000
  s_cbranch_scc1 Lsp_25
Lsx_26:
  s_cmp_eq_u32 s29, 1
  s_cbranch_scc1 Lconv1
  ds_read_b64_tr_b16 v[32:33], v82 offset:3584
  ds_read_b64_tr_b16 v[34:35], v82 offset:3616
  ds_read_b64_tr_b16 v[96:97], v83 offset:416
  ds_read_b64_tr_b16 v[98:99], v83 offset:384
  ds_read_b64_tr_b16 v[36:37], v82 offset:3072
  ds_read_b64_tr_b16 v[38:39], v82 offset:3104
  ds_read_b64_tr_b16 v[100:101], v83 offset:928
  ds_read_b64_tr_b16 v[102:103], v83 offset:896
  ds_read_b64_tr_b16 v[40:41], v82 offset:2560
  ds_read_b64_tr_b16 v[42:43], v82 offset:2592
  ds_read_b64_tr_b16 v[104:105], v83 offset:1440
  ds_read_b64_tr_b16 v[106:107], v83 offset:1408
  s_waitcnt lgkmcnt(8)
  v_mfma_f32_32x32x16_bf16 v[176:191], v[32:35], v[96:99], 0
  ds_read_b64_tr_b16 v[44:45], v82 offset:2048
  ds_read_b64_tr_b16 v[46:47], v82 offset:2080
  s_waitcnt lgkmcnt(6)
  v_mfma_f32_32x32x16_bf16 v[176:191], v[36:39], v[100:103], v[176:191]
  ds_read_b64_tr_b16 v[108:109], v83 offset:1952
  ds_read_b64_tr_b16 v[110:111], v83 offset:1920
  s_waitcnt lgkmcnt(4)
  v_mfma_f32_32x32x16_bf16 v[176:191], v[40:43], v[104:107], v[176:191]
  ds_read_b64_tr_b16 v[48:49], v82 offset:1536
  ds_read_b64_tr_b16 v[50:51], v82 offset:1568
  ds_read_b64_tr_b16 v[112:113], v83 offset:2464
  ds_read_b64_tr_b16 v[114:115], v83 offset:2432
  s_waitcnt lgkmcnt(6)
  v_mfma_f32_32x32x16_bf16 v[160:175], v[44:47], v[96:99], 0
  ds_read_b64_tr_b16 v[52:53], v82 offset:1024
  ds_read_b64_tr_b16 v[54:55], v82 offset:1056
  s_waitcnt lgkmcnt(6)
  v_mfma_f32_32x32x16_bf16 v[176:191], v[44:47], v[108:111], v[176:191]
  ds_read_b64_tr_b16 v[116:117], v83 offset:2976
  ds_read_b64_tr_b16 v[118:119], v83 offset:2944
  s_waitcnt lgkmcnt(6)
  v_mfma_f32_32x32x16_bf16 v[144:159], v[48:51], v[96:99], 0
  ds_read_b64_tr_b16 v[56:57], v82 offset:512
  ds_read_b64_tr_b16 v[58:59], v82 offset:544
  v_mfma_f32_32x32x16_bf16 v[160:175], v[48:51], v[100:103], v[160:175]
  ds_read_b64_tr_b16 v[120:121], v83 offset:3488
  ds_read_b64_tr_b16 v[122:123], v83 offset:3456
  s_waitcnt lgkmcnt(8)
  v_mfma_f32_32x32x16_bf16 v[176:191], v[48:51], v[112:115], v[176:191]
  ds_read_b64_tr_b16 v[60:61], v82 offset:0
  ds_read_b64_tr_b16 v[62:63], v82 offset:32
  s_waitcnt lgkmcnt(8)
  v_mfma_f32_32x32x16_bf16 v[144:159], v[52:55], v[100:103], v[144:159]
  ds_read_b64_tr_b16 v[124:125], v83 offset:4000
  ds_read_b64_tr_b16 v[126:127], v83 offset:3968
  v_mfma_f32_32x32x16_bf16 v[160:175], v[52:55], v[104:107], v[160:175]
  ds_read_b64_tr_b16 v[64:65], v82 offset:3712
  ds_read_b64_tr_b16 v[66:67], v82 offset:3744
  s_waitcnt lgkmcnt(10)
  v_mfma_f32_32x32x16_bf16 v[176:191], v[52:55], v[116:119], v[176:191]
  ds_read_b64_tr_b16 v[192:193], v83 offset:288
  ds_read_b64_tr_b16 v[194:195], v83 offset:256
  s_waitcnt lgkmcnt(10)
  v_mfma_f32_32x32x16_bf16 v[144:159], v[56:59], v[104:107], v[144:159]
  ds_read_b64_tr_b16 v[68:69], v82 offset:3200
  ds_read_b64_tr_b16 v[70:71], v82 offset:3232
  v_mfma_f32_32x32x16_bf16 v[160:175], v[56:59], v[108:111], v[160:175]
  ds_read_b64_tr_b16 v[196:197], v83 offset:800
  ds_read_b64_tr_b16 v[198:199], v83 offset:768
  s_waitcnt lgkmcnt(12)
  v_mfma_f32_32x32x16_bf16 v[176:191], v[56:59], v[120:123], v[176:191]
  ds_read_b64_tr_b16 v[72:73], v82 offset:2688
  ds_read_b64_tr_b16 v[74:75], v82 offset:2720
  s_waitcnt lgkmcnt(12)
  v_mfma_f32_32x32x16_bf16 v[128:143], v[60:63], v[96:99], 0
  ds_read_b64_tr_b16 v[200:201], v83 offset:1312
  ds_read_b64_tr_b16 v[202:203], v83 offset:1280
  v_mfma_f32_32x32x16_bf16 v[144:159], v[60:63], v[108:111], v[144:159]
  ds_read_b64_tr_b16 v[76:77], v82 offset:2176
  ds_read_b64_tr_b16 v[78:79], v82 offset:2208
  v_mfma_f32_32x32x16_bf16 v[160:175], v[60:63], v[112:115], v[160:175]
  ds_read_b64_tr_b16 v[204:205], v83 offset:1824
  ds_read_b64_tr_b16 v[206:207], v83 offset:1792
  s_waitcnt lgkmcnt(15)
  v_mfma_f32_32x32x16_bf16 v[176:191], v[60:63], v[124:127], v[176:191]
  ds_read_b64_tr_b16 v[32:33], v82 offset:1664
  ds_read_b64_tr_b16 v[34:35], v82 offset:1696
  s_waitcnt lgkmcnt(14)
  v_mfma_f32_32x32x16_bf16 v[176:191], v[64:67], v[192:195], v[176:191]
  ds_read_b64_tr_b16 v[208:209], v83 offset:2336
  ds_read_b64_tr_b16 v[210:211], v83 offset:2304
  s_waitcnt lgkmcnt(12)
  v_mfma_f32_32x32x16_bf16 v[176:191], v[68:71], v[196:199], v[176:191]
  ds_read_b64_tr_b16 v[36:37], v82 offset:1152
  ds_read_b64_tr_b16 v[38:39], v82 offset:1184
  s_setprio 1
  s_waitcnt lgkmcnt(10)
  v_mfma_f32_32x32x16_bf16 v[176:191], v[72:75], v[200:203], v[176:191]
  ds_read_b64_tr_b16 v[212:213], v83 offset:2848
  ds_read_b64_tr_b16 v[214:215], v83 offset:2816
  s_waitcnt lgkmcnt(10)
  v_mfma_f32_32x32x16_bf16 v[160:175], v[76:79], v[192:195], v[160:175]
  ds_read_b64_tr_b16 v[40:41], v82 offset:640
  ds_read_b64_tr_b16 v[42:43], v82 offset:672
  s_waitcnt lgkmcnt(10)
  v_mfma_f32_32x32x16_bf16 v[176:191], v[76:79], v[204:207], v[176:191]
  ds_read_b64_tr_b16 v[216:217], v83 offset:3360
  ds_read_b64_tr_b16 v[218:219], v83 offset:3328
  s_waitcnt lgkmcnt(10)
  v_mfma_f32_32x32x16_bf16 v[144:159], v[32:35], v[192:195], v[144:159]
  ds_read_b64_tr_b16 v[44:45], v82 offset:128
  ds_read_b64_tr_b16 v[46:47], v82 offset:160
  v_mfma_f32_32x32x16_bf16 v[160:175], v[32:35], v[196:199], v[160:175]
  ds_read_b64_tr_b16 v[220:221], v83 offset:3872
  ds_read_b64_tr_b16 v[222:223], v83 offset:3840
  s_waitcnt lgkmcnt(12)
  v_mfma_f32_32x32x16_bf16 v[176:191], v[32:35], v[208:211], v[176:191]
  ds_read_b64_tr_b16 v[48:49], v82 offset:3840
  ds_read_b64_tr_b16 v[50:51], v82 offset:3872
  s_waitcnt lgkmcnt(12)
  v_mfma_f32_32x32x16_bf16 v[144:159], v[36:39], v[196:199], v[144:159]
  ds_read_b64_tr_b16 v[96:97], v83 offset:160
  ds_read_b64_tr_b16 v[98:99], v83 offset:128
  v_mfma_f32_32x32x16_bf16 v[160:175], v[36:39], v[200:203], v[160:175]
  ds_read_b64_tr_b16 v[52:53], v82 offset:3328
  ds_read_b64_tr_b16 v[54:55], v82 offset:3360
  s_waitcnt lgkmcnt(14)
  v_mfma_f32_32x32x16_bf16 v[176:191], v[36:39], v[212:215], v[176:191]
  ds_read_b64_tr_b16 v[100:101], v83 offset:672
  ds_read_b64_tr_b16 v[102:103], v83 offset:640
  s_waitcnt lgkmcnt(14)
  v_mfma_f32_32x32x16_bf16 v[144:159], v[40:43], v[200:203], v[144:159]
  ds_read_b64_tr_b16 v[56:57], v82 offset:2816
  ds_read_b64_tr_b16 v[58:59], v82 offset:2848
  v_mfma_f32_32x32x16_bf16 v[160:175], v[40:43], v[204:207], v[160:175]
  ds_read_b64_tr_b16 v[104:105], v83 offset:1184
  ds_read_b64_tr_b16 v[106:107], v83 offset:1152
  s_waitcnt lgkmcnt(15)
  v_mfma_f32_32x32x16_bf16 v[176:191], v[40:43], v[216:219], v[176:191]
  ds_read_b64_tr_b16 v[60:61], v82 offset:2304
  ds_read_b64_tr_b16 v[62:63], v82 offset:2336
  s_waitcnt lgkmcnt(15)
  v_mfma_f32_32x32x16_bf16 v[128:143], v[44:47], v[192:195], v[128:143]
  ds_read_b64_tr_b16 v[108:109], v83 offset:1696
  ds_read_b64_tr_b16 v[110:111], v83 offset:1664
  v_mfma_f32_32x32x16_bf16 v[144:159], v[44:47], v[204:207], v[144:159]
  ds_read_b64_tr_b16 v[64:65], v82 offset:1792
  ds_read_b64_tr_b16 v[66:67], v82 offset:1824
  v_mfma_f32_32x32x16_bf16 v[160:175], v[44:47], v[208:211], v[160:175]
  ds_read_b64_tr_b16 v[112:113], v83 offset:2208
  ds_read_b64_tr_b16 v[114:115], v83 offset:2176
  s_waitcnt lgkmcnt(15)
  v_mfma_f32_32x32x16_bf16 v[176:191], v[44:47], v[220:223], v[176:191]
  ds_read_b64_tr_b16 v[68:69], v82 offset:1280
  ds_read_b64_tr_b16 v[70:71], v82 offset:1312
  v_mfma_f32_32x32x16_bf16 v[176:191], v[48:51], v[96:99], v[176:191]
  ds_read_b64_tr_b16 v[116:117], v83 offset:2720
  ds_read_b64_tr_b16 v[118:119], v83 offset:2688
  s_waitcnt lgkmcnt(15)
  v_mfma_f32_32x32x16_bf16 v[176:191], v[52:55], v[100:103], v[176:191]
  ds_read_b64_tr_b16 v[72:73], v82 offset:768
  ds_read_b64_tr_b16 v[74:75], v82 offset:800
  s_waitcnt lgkmcnt(14)
  v_mfma_f32_32x32x16_bf16 v[176:191], v[56:59], v[104:107], v[176:191]
  ds_read_b64_tr_b16 v[120:121], v83 offset:3232
  ds_read_b64_tr_b16 v[122:123], v83 offset:3200
  s_waitcnt lgkmcnt(14)
  v_mfma_f32_32x32x16_bf16 v[160:175], v[60:63], v[96:99], v[160:175]
  ds_read_b64_tr_b16 v[76:77], v82 offset:256
  ds_read_b64_tr_b16 v[78:79], v82 offset:288
  s_waitcnt lgkmcnt(14)
  v_mfma_f32_32x32x16_bf16 v[176:191], v[60:63], v[108:111], v[176:191]
  ds_read_b64_tr_b16 v[124:125], v83 offset:3744
  ds_read_b64_tr_b16 v[126:127], v83 offset:3712
  s_waitcnt lgkmcnt(14)
  v_mfma_f32_32x32x16_bf16 v[144:159], v[64:67], v[96:99], v[144:159]
  ds_read_b64_tr_b16 v[32:33], v82 offset:3968
  ds_read_b64_tr_b16 v[34:35], v82 offset:4000
  v_mfma_f32_32x32x16_bf16 v[160:175], v[64:67], v[100:103], v[160:175]
  ds_read_b64_tr_b16 v[192:193], v83 offset:32
  ds_read_b64_tr_b16 v[194:195], v83 offset:0
  s_waitcnt lgkmcnt(15)
  v_mfma_f32_32x32x16_bf16 v[176:191], v[64:67], v[112:115], v[176:191]
  ds_read_b64_tr_b16 v[36:37], v82 offset:3456
  ds_read_b64_tr_b16 v[38:39], v82 offset:3488
  s_waitcnt lgkmcnt(15)
  v_mfma_f32_32x32x16_bf16 v[144:159], v[68:71], v[100:103], v[144:159]
  ds_read_b64_tr_b16 v[196:197], v83 offset:544
  ds_read_b64_tr_b16 v[198:199], v83 offset:512
  v_mfma_f32_32x32x16_bf16 v[160:175], v[68:71], v[104:107], v[160:175]
  ds_read_b64_tr_b16 v[40:41], v82 offset:2944
  ds_read_b64_tr_b16 v[42:43], v82 offset:2976
  s_waitcnt lgkmcnt(15)
  v_mfma_f32_32x32x16_bf16 v[176:191], v[68:71], v[116:119], v[176:191]
  ds_read_b64_tr_b16 v[200:201], v83 offset:1056
  ds_read_b64_tr_b16 v[202:203], v83 offset:1024
  v_mfma_f32_32x32x16_bf16 v[144:159], v[72:75], v[104:107], v[144:159]
  ds_read_b64_tr_b16 v[44:45], v82 offset:2432
  ds_read_b64_tr_b16 v[46:47], v82 offset:2464
  v_mfma_f32_32x32x16_bf16 v[160:175], v[72:75], v[108:111], v[160:175]
  ds_read_b64_tr_b16 v[204:205], v83 offset:1568
  ds_read_b64_tr_b16 v[206:207], v83 offset:1536
  s_waitcnt lgkmcnt(15)
  v_mfma_f32_32x32x16_bf16 v[176:191], v[72:75], v[120:123], v[176:191]
  ds_read_b64_tr_b16 v[48:49], v82 offset:1920
  ds_read_b64_tr_b16 v[50:51], v82 offset:1952
  v_mfma_f32_32x32x16_bf16 v[128:143], v[76:79], v[96:99], v[128:143]
  ds_read_b64_tr_b16 v[208:209], v83 offset:2080
  ds_read_b64_tr_b16 v[210:211], v83 offset:2048
  v_mfma_f32_32x32x16_bf16 v[144:159], v[76:79], v[108:111], v[144:159]
  ds_read_b64_tr_b16 v[52:53], v82 offset:1408
  ds_read_b64_tr_b16 v[54:55], v82 offset:1440
  v_mfma_f32_32x32x16_bf16 v[160:175], v[76:79], v[112:115], v[160:175]
  ds_read_b64_tr_b16 v[212:213], v83 offset:2592
  ds_read_b64_tr_b16 v[214:215], v83 offset:2560
  v_mfma_f32_32x32x16_bf16 v[176:191], v[76:79], v[124:127], v[176:191]
  ds_read_b64_tr_b16 v[56:57], v82 offset:896
  ds_read_b64_tr_b16 v[58:59], v82 offset:928
  s_waitcnt lgkmcnt(15)
  v_mfma_f32_32x32x16_bf16 v[176:191], v[32:35], v[192:195], v[176:191]
  ds_read_b64_tr_b16 v[216:217], v83 offset:3104
  ds_read_b64_tr_b16 v[218:219], v83 offset:3072
  v_mfma_f32_32x32x16_bf16 v[176:191], v[36:39], v[196:199], v[176:191]
  ds_read_b64_tr_b16 v[60:61], v82 offset:384
  ds_read_b64_tr_b16 v[62:63], v82 offset:416
  s_waitcnt lgkmcnt(15)
  v_mfma_f32_32x32x16_bf16 v[176:191], v[40:43], v[200:203], v[176:191]
  ds_read_b64_tr_b16 v[220:221], v83 offset:3616
  ds_read_b64_tr_b16 v[222:223], v83 offset:3584
  s_waitcnt lgkmcnt(15)
  v_mfma_f32_32x32x16_bf16 v[176:191], v[44:47], v[204:207], v[176:191]
  s_waitcnt lgkmcnt(12)
  v_mfma_f32_32x32x16_bf16 v[176:191], v[48:51], v[208:211], v[176:191]
  s_waitcnt lgkmcnt(8)
  v_mfma_f32_32x32x16_bf16 v[176:191], v[52:55], v[212:215], v[176:191]
  ds_read_b32 v5, v13 offset:208
  s_waitcnt lgkmcnt(5)
  v_mfma_f32_32x32x16_bf16 v[176:191], v[56:59], v[216:219], v[176:191]
  s_waitcnt lgkmcnt(1)
  v_mfma_f32_32x32x16_bf16 v[176:191], v[60:63], v[220:223], v[176:191]
  s_setprio 3
  s_waitcnt lgkmcnt(0)
  v_readfirstlane_b32 s65, v5
  s_cmp_ge_u32 s65, 4
  s_cbranch_scc1 Lsx_29
  s_mov_b32 s64, 0
Lsp_28:
  ds_read_b32 v5, v13 offset:208
  s_add_u32 s64, s64, 1
  s_waitcnt lgkmcnt(0)
  v_readfirstlane_b32 s65, v5
  s_cmp_ge_u32 s65, 4
  s_cbranch_scc1 Lsx_29
  s_sleep 1
  s_cmp_lt_u32 s64, 200000
  s_cbranch_scc1 Lsp_28
Lsx_29:
  s_setprio 1
  ds_write_addtid_b32 v16 offset:8208
  ds_write_addtid_b32 v16 offset:16416
  ds_write_addtid_b32 v16 offset:24624
  v_mfma_f32_32x32x16_bf16 v[160:175], v[44:47], v[192:195], v[160:175]
  v_mfma_f32_32x32x16_bf16 v[160:175], v[48:51], v[196:199], v[160:175]
  s_nop 0
  ds_write_addtid_b32 v176 offset:7168
  ds_write_addtid_b32 v177 offset:15380
  ds_write_addtid_b32 v178 offset:23592
  ds_write_addtid_b32 v179 offset:31804
  v_mfma_f32_32x32x16_bf16 v[160:175], v[52:55], v[200:203], v[160:175]
  ds_write_addtid_b32 v180 offset:7424
  ds_write_addtid_b32 v181 offset:15636
  ds_write_addtid_b32 v182 offset:23848
  ds_write_addtid_b32 v183 offset:32060
  v_mfma_f32_32x32x16_bf16 v[160:175], v[56:59], v[204:207], v[160:175]
  ds_write_addtid_b32 v184 offset:7680
  ds_write_addtid_b32 v185 offset:15892
  ds_write_addtid_b32 v186 offset:24104
  ds_write_addtid_b32 v187 offset:32316
  v_mfma_f32_32x32x16_bf16 v[160:175], v[60:63], v[208:211], v[160:175]
  ds_write_addtid_b32 v188 offset:7936
  ds_write_addtid_b32 v189 offset:16148
  ds_write_addtid_b32 v190 offset:24360
  ds_write_addtid_b32 v191 offset:32572
  v_mfma_f32_32x32x16_bf16 v[144:159], v[48:51], v[192:195], v[144:159]
  v_mfma_f32_32x32x16_bf16 v[144:159], v[52:55], v[196:199], v[144:159]
  s_nop 5
  ds_write_addtid_b32 v160 offset:4096
  ds_write_addtid_b32 v161 offset:12308
  ds_write_addtid_b32 v162 offset:20520
  ds_write_addtid_b32 v163 offset:28732
  v_mfma_f32_32x32x16_bf16 v[144:159], v[56:59], v[200:203], v[144:159]
  ds_write_addtid_b32 v164 offset:4352
  ds_write_addtid_b32 v165 offset:12564
  ds_write_addtid_b32 v166 offset:20776
  ds_write_addtid_b32 v167 offset:28988
  v_mfma_f32_32x32x16_bf16 v[144:159], v[60:63], v[204:207], v[144:159]
  ds_write_addtid_b32 v168 offset:4608
  ds_write_addtid_b32 v169 offset:12820
  ds_write_addtid_b32 v170 offset:21032
  ds_write_addtid_b32 v171 offset:29244
  v_mfma_f32_32x32x16_bf16 v[128:143], v[60:63], v[192:195], v[128:143]
  ds_read_b32 v5, v13 offset:48
  ds_write_addtid_b32 v172 offset:4864
  ds_write_addtid_b32 v173 offset:13076
  ds_write_addtid_b32 v174 offset:21288
  ds_write_addtid_b32 v175 offset:29500
  s_nop 1
  ds_write_addtid_b32 v144 offset:3072
  ds_write_addtid_b32 v145 offset:11284
  ds_write_addtid_b32 v146 offset:19496
  ds_write_addtid_b32 v147 offset:27708
  ds_write_addtid_b32 v148 offset:3328
  ds_write_addtid_b32 v149 offset:11540
  ds_write_addtid_b32 v150 offset:19752
  ds_write_addtid_b32 v151 offset:27964
  ds_write_addtid_b32 v152 offset:3584
  ds_write_addtid_b32 v153 offset:11796
  ds_write_addtid_b32 v154 offset:20008
  ds_write_addtid_b32 v155 offset:28220
  ds_write_addtid_b32 v156 offset:3840
  ds_write_addtid_b32 v157 offset:12052
  ds_write_addtid_b32 v158 offset:20264
  ds_write_addtid_b32 v159 offset:28476
  ds_write_addtid_b32 v128 offset:0
  ds_write_addtid_b32 v129 offset:8212
  ds_write_addtid_b32 v130 offset:16424
  ds_write_addtid_b32 v131 offset:24636
  ds_write_addtid_b32 v132 offset:256
  ds_write_addtid_b32 v133 offset:8468
  ds_write_addtid_b32 v134 offset:16680
  ds_write_addtid_b32 v135 offset:24892
  ds_write_addtid_b32 v136 offset:512
  ds_write_addtid_b32 v137 offset:8724
  ds_write_addtid_b32 v138 offset:16936
  ds_write_addtid_b32 v139 offset:25148
  ds_write_addtid_b32 v140 offset:768
  ds_write_addtid_b32 v141 offset:8980
  ds_write_addtid_b32 v142 offset:17192
  ds_write_addtid_b32 v143 offset:25404
  s_branch Lconvd
Lconv1:
  ds_read_b64_tr_b16 v[32:33], v82 offset:3072
  ds_read_b64_tr_b16 v[34:35], v82 offset:3104
  ds_read_b64_tr_b16 v[96:97], v83 offset:416
  ds_read_b64_tr_b16 v[98:99], v83 offset:384
  ds_read_b64_tr_b16 v[36:37], v82 offset:2560
  ds_read_b64_tr_b16 v[38:39], v82 offset:2592
  ds_read_b64_tr_b16 v[100:101], v83 offset:928
  ds_read_b64_tr_b16 v[102:103], v83 offset:896
  ds_read_b64_tr_b16 v[40:41], v82 offset:2048
  ds_read_b64_tr_b16 v[42:43], v82 offset:2080
  ds_read_b64_tr_b16 v[104:105], v83 offset:1440
  ds_read_b64_tr_b16 v[106:107], v83 offset:1408
  s_waitcnt lgkmcnt(8)
  v_mfma_f32_32x32x16_bf16 v[176:191], v[32:35], v[96:99], 0
  ds_read_b64_tr_b16 v[44:45], v82 offset:1536
  ds_read_b64_tr_b16 v[46:47], v82 offset:1568
  s_waitcnt lgkmcnt(8)
  v_mfma_f32_32x32x16_bf16 v[160:175], v[36:39], v[96:99], 0
  ds_read_b64_tr_b16 v[108:109], v83 offset:1952
  ds_read_b64_tr_b16 v[110:111], v83 offset:1920
  s_waitcnt lgkmcnt(8)
  v_mfma_f32_32x32x16_bf16 v[176:191], v[36:39], v[100:103], v[176:191]
  ds_read_b64_tr_b16 v[48:49], v82 offset:1024
  ds_read_b64_tr_b16 v[50:51], v82 offset:1056
  s_waitcnt lgkmcnt(8)
  v_mfma_f32_32x32x16_bf16 v[160:175], v[40:43], v[100:103], v[160:175]
  ds_read_b64_tr_b16 v[112:113], v83 offset:2464
  ds_read_b64_tr_b16 v[114:115], v83 offset:2432
  s_waitcnt lgkmcnt(8)
  v_mfma_f32_32x32x16_bf16 v[176:191], v[40:43], v[104:107], v[176:191]
  ds_read_b64_tr_b16 v[52:53], v82 offset:512
  ds_read_b64_tr_b16 v[54:55], v82 offset:544
  s_waitcnt lgkmcnt(8)
  v_mfma_f32_32x32x16_bf16 v[160:175], v[44:47], v[104:107], v[160:175]
  ds_read_b64_tr_b16 v[116:117], v83 offset:2976
  ds_read_b64_tr_b16 v[118:119], v83 offset:2944
  s_waitcnt lgkmcnt(8)
  v_mfma_f32_32x32x16_bf16 v[176:191], v[44:47], v[108:111], v[176:191]
  ds_read_b64_tr_b16 v[56:57], v82 offset:0
  ds_read_b64_tr_b16 v[58:59], v82 offset:32
  s_waitcnt lgkmcnt(8)
  v_mfma_f32_32x32x16_bf16 v[144:159], v[48:51], v[96:99], 0
  ds_read_b64_tr_b16 v[120:121], v83 offset:3488
  ds_read_b64_tr_b16 v[122:123], v83 offset:3456
  v_mfma_f32_32x32x16_bf16 v[160:175], v[48:51], v[108:111], v[160:175]
  ds_read_b64_tr_b16 v[60:61], v82 offset:3200
  ds_read_b64_tr_b16 v[62:63], v82 offset:3232
  s_waitcnt lgkmcnt(10)
  v_mfma_f32_32x32x16_bf16 v[176:191], v[48:51], v[112:115], v[176:191]
  ds_read_b64_tr_b16 v[192:193], v83 offset:288
  ds_read_b64_tr_b16 v[194:195], v83 offset:256
  s_waitcnt lgkmcnt(10)
  v_mfma_f32_32x32x16_bf16 v[128:143], v[52:55], v[96:99], 0
  ds_read_b64_tr_b16 v[64:65], v82 offset:2688
  ds_read_b64_tr_b16 v[66:67], v82 offset:2720
  v_mfma_f32_32x32x16_bf16 v[144:159], v[52:55], v[100:103], v[144:159]
  ds_read_b64_tr_b16 v[196:197], v83 offset:800
  ds_read_b64_tr_b16 v[198:199], v83 offset:768
  v_mfma_f32_32x32x16_bf16 v[160:175], v[52:55], v[112:115], v[160:175]
  ds_read_b64_tr_b16 v[68:69], v82 offset:2176
  ds_read_b64_tr_b16 v[70:71], v82 offset:2208
  s_waitcnt lgkmcnt(14)
  v_mfma_f32_32x32x16_bf16 v[176:191], v[52:55], v[116:119], v[176:191]
  ds_read_b64_tr_b16 v[200:201], v83 offset:1312
  ds_read_b64_tr_b16 v[202:203], v83 offset:1280
  s_waitcnt lgkmcnt(14)
  v_mfma_f32_32x32x16_bf16 v[128:143], v[56:59], v[100:103], v[128:143]
  ds_read_b64_tr_b16 v[72:73], v82 offset:1664
  ds_read_b64_tr_b16 v[74:75], v82 offset:1696
  v_mfma_f32_32x32x16_bf16 v[144:159], v[56:59], v[104:107], v[144:159]
  ds_read_b64_tr_b16 v[204:205], v83 offset:1824
  ds_read_b64_tr_b16 v[206:207], v83 offset:1792
  v_mfma_f32_32x32x16_bf16 v[160:175], v[56:59], v[116:119], v[160:175]
  ds_read_b64_tr_b16 v[76:77], v82 offset:1152
  ds_read_b64_tr_b16 v[78:79], v82 offset:1184
  s_waitcnt lgkmcnt(15)
  v_mfma_f32_32x32x16_bf16 v[176:191], v[56:59], v[120:123], v[176:191]
  ds_read_b64_tr_b16 v[208:209], v83 offset:2336
  ds_read_b64_tr_b16 v[210:211], v83 offset:2304
  s_waitcnt lgkmcnt(15)
  v_mfma_f32_32x32x16_bf16 v[176:191], v[60:63], v[192:195], v[176:191]
  ds_read_b64_tr_b16 v[32:33], v82 offset:640
  ds_read_b64_tr_b16 v[34:35], v82 offset:672
  s_waitcnt lgkmcnt(15)
  v_mfma_f32_32x32x16_bf16 v[160:175], v[64:67], v[192:195], v[160:175]
  ds_read_b64_tr_b16 v[212:213], v83 offset:2848
  ds_read_b64_tr_b16 v[214:215], v83 offset:2816
  s_setprio 1
  s_waitcnt lgkmcnt(15)
  v_mfma_f32_32x32x16_bf16 v[176:191], v[64:67], v[196:199], v[176:191]
  ds_read_b64_tr_b16 v[36:37], v82 offset:128
  ds_read_b64_tr_b16 v[38:39], v82 offset:160
  s_waitcnt lgkmcnt(15)
  v_mfma_f32_32x32x16_bf16 v[160:175], v[68:71], v[196:199], v[160:175]
  ds_read_b64_tr_b16 v[216:217], v83 offset:3360
  ds_read_b64_tr_b16 v[218:219], v83 offset:3328
  s_waitcnt lgkmcnt(15)
  v_mfma_f32_32x32x16_bf16 v[176:191], v[68:71], v[200:203], v[176:191]
  ds_read_b64_tr_b16 v[40:41], v82 offset:3328
  ds_read_b64_tr_b16 v[42:43], v82 offset:3360
  s_waitcnt lgkmcnt(15)
  v_mfma_f32_32x32x16_bf16 v[160:175], v[72:75], v[200:203], v[160:175]
  ds_read_b64_tr_b16 v[96:97], v83 offset:160
  ds_read_b64_tr_b16 v[98:99], v83 offset:128
  s_waitcnt lgkmcnt(15)
  v_mfma_f32_32x32x16_bf16 v[176:191], v[72:75], v[204:207], v[176:191]
  ds_read_b64_tr_b16 v[44:45], v82 offset:2816
  ds_read_b64_tr_b16 v[46:47], v82 offset:2848
  s_waitcnt lgkmcnt(15)
  v_mfma_f32_32x32x16_bf16 v[144:159], v[76:79], v[192:195], v[144:159]
  ds_read_b64_tr_b16 v[100:101], v83 offset:672
  ds_read_b64_tr_b16 v[102:103], v83 offset:640
  v_mfma_f32_32x32x16_bf16 v[160:175], v[76:79], v[204:207], v[160:175]
  ds_read_b64_tr_b16 v[48:49], v82 offset:2304
  ds_read_b64_tr_b16 v[50:51], v82 offset:2336
  s_waitcnt lgkmcnt(15)
  v_mfma_f32_32x32x16_bf16 v[176:191], v[76:79], v[208:211], v[176:191]
  ds_read_b64_tr_b16 v[104:105], v83 offset:1184
  ds_read_b64_tr_b16 v[106:107], v83 offset:1152
  v_mfma_f32_32x32x16_bf16 v[128:143], v[32:35], v[192:195], v[128:143]
  ds_read_b64_tr_b16 v[52:53], v82 offset:1792
  ds_read_b64_tr_b16 v[54:55], v82 offset:1824
  v_mfma_f32_32x32x16_bf16 v[144:159], v[32:35], v[196:199], v[144:159]
  ds_read_b64_tr_b16 v[108:109], v83 offset:1696
  ds_read_b64_tr_b16 v[110:111], v83 offset:1664
  v_mfma_f32_32x32x16_bf16 v[160:175], v[32:35], v[208:211], v[160:175]
  ds_read_b64_tr_b16 v[56:57], v82 offset:1280
  ds_read_b64_tr_b16 v[58:59], v82 offset:1312
  s_waitcnt lgkmcnt(15)
  v_mfma_f32_32x32x16_bf16 v[176:191], v[32:35], v[212:215], v[176:191]
  ds_read_b64_tr_b16 v[112:113], v83 offset:2208
  ds_read_b64_tr_b16 v[114:115], v83 offset:2176
  v_mfma_f32_32x32x16_bf16 v[128:143], v[36:39], v[196:199], v[128:143]
  ds_read_b64_tr_b16 v[60:61], v82 offset:768
  ds_read_b64_tr_b16 v[62:63], v82 offset:800
  v_mfma_f32_32x32x16_bf16 v[144:159], v[36:39], v[200:203], v[144:159]
  ds_read_b64_tr_b16 v[116:117], v83 offset:2720
  ds_read_b64_tr_b16 v[118:119], v83 offset:2688
  v_mfma_f32_32x32x16_bf16 v[160:175], v[36:39], v[212:215], v[160:175]
  v_mfma_f32_32x32x16_bf16 v[176:191], v[36:39], v[216:219], v[176:191]
  ds_read_b64_tr_b16 v[64:65], v82 offset:256
  ds_read_b64_tr_b16 v[66:67], v82 offset:288
  s_waitcnt lgkmcnt(15)
  v_mfma_f32_32x32x16_bf16 v[176:191], v[40:43], v[96:99], v[176:191]
  ds_read_b64_tr_b16 v[120:121], v83 offset:3232
  ds_read_b64_tr_b16 v[122:123], v83 offset:3200
  v_mfma_f32_32x32x16_bf16 v[160:175], v[44:47], v[96:99], v[160:175]
  ds_read_b64_tr_b16 v[68:69], v82 offset:3456
  ds_read_b64_tr_b16 v[70:71], v82 offset:3488
  v_mfma_f32_32x32x16_bf16 v[176:191], v[44:47], v[100:103], v[176:191]
  ds_read_b64_tr_b16 v[192:193], v83 offset:32
  ds_read_b64_tr_b16 v[194:195], v83 offset:0
  v_mfma_f32_32x32x16_bf16 v[160:175], v[48:51], v[100:103], v[160:175]
  ds_read_b64_tr_b16 v[72:73], v82 offset:2944
  ds_read_b64_tr_b16 v[74:75], v82 offset:2976
  s_waitcnt lgkmcnt(15)
  v_mfma_f32_32x32x16_bf16 v[176:191], v[48:51], v[104:107], v[176:191]
  ds_read_b64_tr_b16 v[196:197], v83 offset:544
  ds_read_b64_tr_b16 v[198:199], v83 offset:512
  v_mfma_f32_32x32x16_bf16 v[160:175], v[52:55], v[104:107], v[160:175]
  ds_read_b64_tr_b16 v[76:77], v82 offset:2432
  ds_read_b64_tr_b16 v[78:79], v82 offset:2464
  v_mfma_f32_32x32x16_bf16 v[176:191], v[52:55], v[108:111], v[176:191]
  ds_read_b64_tr_b16 v[200:201], v83 offset:1056
  ds_read_b64_tr_b16 v[202:203], v83 offset:1024
  v_mfma_f32_32x32x16_bf16 v[144:159], v[56:59], v[96:99], v[144:159]
  ds_read_b64_tr_b16 v[32:33], v82 offset:1920
  ds_read_b64_tr_b16 v[34:35], v82 offset:1952
  v_mfma_f32_32x32x16_bf16 v[160:175], v[56:59], v[108:111], v[160:175]
  ds_read_b64_tr_b16 v[204:205], v83 offset:1568
  ds_read_b64_tr_b16 v[206:207], v83 offset:1536
  s_waitcnt lgkmcnt(15)
  v_mfma_f32_32x32x16_bf16 v[176:191], v[56:59], v[112:115], v[176:191]
  ds_read_b64_tr_b16 v[36:37], v82 offset:1408
  ds_read_b64_tr_b16 v[38:39], v82 offset:1440
  v_mfma_f32_32x32x16_bf16 v[128:143], v[60:63], v[96:99], v[128:143]
  ds_read_b64_tr_b16 v[208:209], v83 offset:2080
  ds_read_b64_tr_b16 v[210:211], v83 offset:2048
  v_mfma_f32_32x32x16_bf16 v[144:159], v[60:63], v[100:103], v[144:159]
  v_mfma_f32_32x32x16_bf16 v[160:175], v[60:63], v[112:115], v[160:175]
  v_mfma_f32_32x32x16_bf16 v[176:191], v[60:63], v[116:119], v[176:191]
  ds_read_b64_tr_b16 v[40:41], v82 offset:896
  ds_read_b64_tr_b16 v[42:43], v82 offset:928
  v_mfma_f32_32x32x16_bf16 v[128:143], v[64:67], v[100:103], v[128:143]
  ds_read_b64_tr_b16 v[212:213], v83 offset:2592
  ds_read_b64_tr_b16 v[214:215], v83 offset:2560
  v_mfma_f32_32x32x16_bf16 v[144:159], v[64:67], v[104:107], v[144:159]
  v_mfma_f32_32x32x16_bf16 v[160:175], v[64:67], v[116:119], v[160:175]
  v_mfma_f32_32x32x16_bf16 v[176:191], v[64:67], v[120:123], v[176:191]
  ds_read_b64_tr_b16 v[44:45], v82 offset:384
  ds_read_b64_tr_b16 v[46:47], v82 offset:416
  s_waitcnt lgkmcnt(15)
  v_mfma_f32_32x32x16_bf16 v[176:191], v[68:71], v[192:195], v[176:191]
  ds_read_b64_tr_b16 v[216:217], v83 offset:3104
  ds_read_b64_tr_b16 v[218:219], v83 offset:3072
  v_mfma_f32_32x32x16_bf16 v[176:191], v[72:75], v[196:199], v[176:191]
  s_waitcnt lgkmcnt(15)
  v_mfma_f32_32x32x16_bf16 v[176:191], v[76:79], v[200:203], v[176:191]
  s_waitcnt lgkmcnt(12)
  v_mfma_f32_32x32x16_bf16 v[176:191], v[32:35], v[204:207], v[176:191]
  s_waitcnt lgkmcnt(8)
  v_mfma_f32_32x32x16_bf16 v[176:191], v[36:39], v[208:211], v[176:191]
  ds_read_b32 v5, v13 offset:208
  s_waitcnt lgkmcnt(5)
  v_mfma_f32_32x32x16_bf16 v[176:191], v[40:43], v[212:215], v[176:191]
  s_waitcnt lgkmcnt(1)
  v_mfma_f32_32x32x16_bf16 v[176:191], v[44:47], v[216:219], v[176:191]
  s_setprio 3
  s_waitcnt lgkmcnt(0)
  v_readfirstlane_b32 s65, v5
  s_cmp_ge_u32 s65, 4
  s_cbranch_scc1 Lsx_32
  s_mov_b32 s64, 0
Lsp_31:
  ds_read_b32 v5, v13 offset:208
  s_add_u32 s64, s64, 1
  s_waitcnt lgkmcnt(0)
  v_readfirstlane_b32 s65, v5
  s_cmp_ge_u32 s65, 4
  s_cbranch_scc1 Lsx_32
  s_sleep 1
  s_cmp_lt_u32 s64, 200000
  s_cbranch_scc1 Lsp_31
Lsx_32:
  s_setprio 1
  v_mfma_f32_32x32x16_bf16 v[160:175], v[72:75], v[192:195], v[160:175]
  v_mfma_f32_32x32x16_bf16 v[160:175], v[76:79], v[196:199], v[160:175]
  s_nop 3
  ds_write_addtid_b32 v176 offset:6144
  ds_write_addtid_b32 v177 offset:14356
  ds_write_addtid_b32 v178 offset:22568
  ds_write_addtid_b32 v179 offset:30780
  v_mfma_f32_32x32x16_bf16 v[160:175], v[32:35], v[200:203], v[160:175]
  ds_write_addtid_b32 v180 offset:6400
  ds_write_addtid_b32 v181 offset:14612
  ds_write_addtid_b32 v182 offset:22824
  ds_write_addtid_b32 v183 offset:31036
  v_mfma_f32_32x32x16_bf16 v[160:175], v[36:39], v[204:207], v[160:175]
  ds_write_addtid_b32 v184 offset:6656
  ds_write_addtid_b32 v185 offset:14868
  ds_write_addtid_b32 v186 offset:23080
  ds_write_addtid_b32 v187 offset:31292
  v_mfma_f32_32x32x16_bf16 v[160:175], v[40:43], v[208:211], v[160:175]
  ds_write_addtid_b32 v188 offset:6912
  ds_write_addtid_b32 v189 offset:15124
  ds_write_addtid_b32 v190 offset:23336
  ds_write_addtid_b32 v191 offset:31548
  v_mfma_f32_32x32x16_bf16 v[160:175], v[44:47], v[212:215], v[160:175]
  v_mfma_f32_32x32x16_bf16 v[144:159], v[36:39], v[192:195], v[144:159]
  v_mfma_f32_32x32x16_bf16 v[144:159], v[40:43], v[196:199], v[144:159]
  s_nop 9
  ds_write_addtid_b32 v160 offset:5120
  ds_write_addtid_b32 v161 offset:13332
  ds_write_addtid_b32 v162 offset:21544
  ds_write_addtid_b32 v163 offset:29756
  v_mfma_f32_32x32x16_bf16 v[144:159], v[44:47], v[200:203], v[144:159]
  ds_write_addtid_b32 v164 offset:5376
  ds_write_addtid_b32 v165 offset:13588
  ds_write_addtid_b32 v166 offset:21800
  ds_write_addtid_b32 v167 offset:30012
  v_mfma_f32_32x32x16_bf16 v[128:143], v[40:43], v[192:195], v[128:143]
  ds_write_addtid_b32 v168 offset:5632
  ds_write_addtid_b32 v169 offset:13844
  ds_write_addtid_b32 v170 offset:22056
  ds_write_addtid_b32 v171 offset:30268
  v_mfma_f32_32x32x16_bf16 v[128:143], v[44:47], v[196:199], v[128:143]
  ds_read_b32 v5, v13 offset:48
  ds_write_addtid_b32 v172 offset:5888
  ds_write_addtid_b32 v173 offset:14100
  ds_write_addtid_b32 v174 offset:22312
  ds_write_addtid_b32 v175 offset:30524
  ds_write_addtid_b32 v144 offset:2048
  ds_write_addtid_b32 v145 offset:10260
  ds_write_addtid_b32 v146 offset:18472
  ds_write_addtid_b32 v147 offset:26684
  ds_write_addtid_b32 v148 offset:2304
  ds_write_addtid_b32 v149 offset:10516
  ds_write_addtid_b32 v150 offset:18728
  ds_write_addtid_b32 v151 offset:26940
  ds_write_addtid_b32 v152 offset:2560
  ds_write_addtid_b32 v153 offset:10772
  ds_write_addtid_b32 v154 offset:18984
  ds_write_addtid_b32 v155 offset:27196
  ds_write_addtid_b32 v156 offset:2816
  ds_write_addtid_b32 v157 offset:11028
  ds_write_addtid_b32 v158 offset:19240
  ds_write_addtid_b32 v159 offset:27452
  ds_write_addtid_b32 v128 offset:1024
  ds_write_addtid_b32 v129 offset:9236
  ds_write_addtid_b32 v130 offset:17448
  ds_write_addtid_b32 v131 offset:25660
  ds_write_addtid_b32 v132 offset:1280
  ds_write_addtid_b32 v133 offset:9492
  ds_write_addtid_b32 v134 offset:17704
  ds_write_addtid_b32 v135 offset:25916
  ds_write_addtid_b32 v136 offset:1536
  ds_write_addtid_b32 v137 offset:9748
  ds_write_addtid_b32 v138 offset:17960
  ds_write_addtid_b32 v139 offset:26172
  ds_write_addtid_b32 v140 offset:1792
  ds_write_addtid_b32 v141 offset:10004
  ds_write_addtid_b32 v142 offset:18216
  ds_write_addtid_b32 v143 offset:26428
Lconvd:
  s_mov_b64 exec, 1
  ds_add_u32 v13, v12 offset:176
  s_mov_b64 exec, -1
  s_setprio 3
  s_waitcnt lgkmcnt(15)
  v_readfirstlane_b32 s65, v5
  s_cmp_ge_u32 s65, 4
  s_cbranch_scc1 Lsx_35
  s_mov_b32 s64, 0
Lsp_34:
  ds_read_b32 v5, v13 offset:48
  s_add_u32 s64, s64, 1
  s_waitcnt lgkmcnt(0)
  v_readfirstlane_b32 s65, v5
  s_cmp_ge_u32 s65, 4
  s_cbranch_scc1 Lsx_35
  s_sleep 1
  s_cmp_lt_u32 s64, 200000
  s_cbranch_scc1 Lsp_34
Lsx_35:
  ds_read_b128 v[8:11], v2 offset:4096
  ds_read_b128 v[84:87], v2 offset:5120
  ds_read_b128 v[88:91], v2 offset:6144
  ds_read_b128 v[0:3], v2 offset:7168
  s_and_b32 s66, s4, 3
  s_mov_b32 s69, 0x8000
  s_mov_b32 s24, s56
  s_mov_b32 s25, s57
  s_mov_b32 s26, 3670016
  s_mov_b32 s27, 0x20000
  s_mov_b32 s20, s54
  s_mov_b32 s21, s55
  s_mov_b32 s22, 401408
  s_mov_b32 s23, 0x20000
  s_mov_b32 s64, 0
Lsp_37:
  ds_read_b32 v5, v13 offset:176
  s_add_u32 s64, s64, 1
  s_waitcnt lgkmcnt(0)
  v_readfirstlane_b32 s65, v5
  s_cmp_ge_u32 s65, 4
  s_cbranch_scc1 Lsx_38
  s_sleep 1
  s_cmp_lt_u32 s64, 200000
  s_cbranch_scc1 Lsp_37
Lsx_38:
  ds_read_b128 v[96:99], v0 offset:0
  ds_read_b128 v[100:103], v0 offset:8208
  ds_read_b128 v[104:107], v0 offset:16416
  ds_read_b128 v[108:111], v0 offset:24624
  ds_read_b128 v[112:115], v0 offset:16
  ds_read_b128 v[116:119], v0 offset:8224
  ds_read_b128 v[120:123], v0 offset:16432
  ds_read_b128 v[124:127], v0 offset:24640
  ds_read_b128 v[128:131], v0 offset:1024
  ds_read_b128 v[132:135], v0 offset:9232
  ds_read_b128 v[136:139], v0 offset:17440
  ds_read_b128 v[140:143], v0 offset:25648
  ds_read_b128 v[144:147], v0 offset:1040
  ds_read_b128 v[148:151], v0 offset:9248
  ds_read_b128 v[152:155], v0 offset:17456
  ds_read_b128 v[156:159], v0 offset:25664
  buffer_store_dwordx4 v[16:19], v9, s[16:19], 0 offen sc1
  buffer_store_dwordx4 v[16:19], v9, s[16:19], 0 offen offset:1024 sc1
  s_waitcnt lgkmcnt(14)
  v_pk_add_f32 v[96:97], v[96:97], v[100:101]
  v_pk_add_f32 v[98:99], v[98:99], v[102:103]
  s_waitcnt lgkmcnt(12)
  v_pk_add_f32 v[104:105], v[104:105], v[108:109]
  v_pk_add_f32 v[106:107], v[106:107], v[110:111]
  v_pk_add_f32 v[96:97], v[96:97], v[104:105]
  v_pk_add_f32 v[98:99], v[98:99], v[106:107]
  v_cvt_pk_bf16_f32 v24, v96, v97
  v_cvt_pk_bf16_f32 v25, v98, v99
  s_waitcnt lgkmcnt(10)
  v_pk_add_f32 v[112:113], v[112:113], v[116:117]
  v_pk_add_f32 v[114:115], v[114:115], v[118:119]
  s_waitcnt lgkmcnt(8)
  v_pk_add_f32 v[120:121], v[120:121], v[124:125]
  v_pk_add_f32 v[122:123], v[122:123], v[126:127]
  v_pk_add_f32 v[112:113], v[112:113], v[120:121]
  v_pk_add_f32 v[114:115], v[114:115], v[122:123]
  v_cvt_pk_bf16_f32 v26, v112, v113
  v_cvt_pk_bf16_f32 v27, v114, v115
  buffer_store_dwordx4 v[24:27], v10, s[16:19], 0 offen sc1
  s_waitcnt lgkmcnt(6)
  v_pk_add_f32 v[128:129], v[128:129], v[132:133]
  v_pk_add_f32 v[130:131], v[130:131], v[134:135]
  s_waitcnt lgkmcnt(4)
  v_pk_add_f32 v[136:137], v[136:137], v[140:141]
  v_pk_add_f32 v[138:139], v[138:139], v[142:143]
  v_pk_add_f32 v[128:129], v[128:129], v[136:137]
  v_pk_add_f32 v[130:131], v[130:131], v[138:139]
  v_cvt_pk_bf16_f32 v28, v128, v129
  v_cvt_pk_bf16_f32 v29, v130, v131
  s_waitcnt lgkmcnt(2)
  v_pk_add_f32 v[144:145], v[144:145], v[148:149]
  v_pk_add_f32 v[146:147], v[146:147], v[150:151]
  s_waitcnt lgkmcnt(0)
  v_pk_add_f32 v[152:153], v[152:153], v[156:157]
  v_pk_add_f32 v[154:155], v[154:155], v[158:159]
  v_pk_add_f32 v[144:145], v[144:145], v[152:153]
  v_pk_add_f32 v[146:147], v[146:147], v[154:155]
  v_cvt_pk_bf16_f32 v30, v144, v145
  v_cvt_pk_bf16_f32 v31, v146, v147
  buffer_store_dwordx4 v[28:31], v10, s[16:19], s69 offen sc1
  s_setprio 1
La_pub:
  s_lshl_b32 s67, s68, 7
  s_add_u32 s67, s67, 131072
  s_mul_i32 s30, s3, 100352
  s_lshl_b32 s64, s66, 8
  s_add_u32 s30, s30, s64
  s_mul_i32 m0, s3, 28672
  s_waitcnt vmcnt(0)
  s_mov_b64 exec, 1
  ds_add_rtn_u32 v5, v13, v12 offset:80
  s_waitcnt lgkmcnt(0)
  v_readfirstlane_b32 s63, v5
  s_cmp_lg_u32 s63, 3
  s_cbranch_scc1 Lnf_40
  buffer_store_dword v7, v16, s[16:19], s67 offen sc1
Lnf_40:
  s_mov_b64 exec, -1
  s_mov_b32 s64, 0
Lsp_42:
  ds_read_b32 v5, v13 offset:80
  s_add_u32 s64, s64, 1
  s_waitcnt lgkmcnt(0)
  v_readfirstlane_b32 s65, v5
  s_cmp_ge_u32 s65, 4
  s_cbranch_scc1 Lsx_43
  s_sleep 2
  s_cmp_lt_u32 s64, 200000
  s_cbranch_scc1 Lsp_42
Lsx_43:
  s_mov_b32 s65, 0
Lwo:
  buffer_load_dwordx4 v90, s[20:23], s30 offen lds
  s_add_u32 m0, m0, 1024
  s_add_u32 s30, s30, 3584
  buffer_load_dwordx4 v90, s[20:23], s30 offen lds
  s_add_u32 m0, m0, 1024
  s_add_u32 s30, s30, 3584
  s_add_u32 s65, s65, 1
  s_waitcnt vmcnt(2)
  s_cmp_lt_u32 s65, 8
  s_cbranch_scc1 Lwo
  s_cmp_lg_u32 s3, 0
  s_cbranch_scc1 La_nog
  s_mov_b32 s64, 0
Lpf_45:
  buffer_load_dword v6, v91, s[16:19], 0 offen sc1
Lpe_47:
  s_add_u32 s64, s64, 1
  s_waitcnt vmcnt(0)
  v_cmp_ne_u32 vcc, s62, v6
  s_cbranch_vccz Lpx_46
  s_sleep 8
  s_cmp_lt_u32 s64, 200000
  s_cbranch_scc1 Lpf_45
Lpx_46:
  s_mov_b64 exec, 1
  ds_add_u32 v13, v12 offset:240
  s_mov_b64 exec, -1
La_nog:
La_hr:
  s_mov_b32 s64, 0
Lsp_48:
  ds_read_b32 v6, v13 offset:240
  s_add_u32 s64, s64, 1
  s_waitcnt lgkmcnt(0)
  v_readfirstlane_b32 s65, v6
  s_cmp_ge_u32 s65, 1
  s_cbranch_scc1 Lsx_49
  s_sleep 8
  s_cmp_lt_u32 s64, 200000
  s_cbranch_scc1 Lsp_48
Lsx_49:
  buffer_load_dwordx4 v[48:51], v11, s[16:19], 0 offen offset:0 sc1
  buffer_load_dwordx4 v[52:55], v11, s[16:19], 0 offen offset:1024 sc1
  s_waitcnt vmcnt(1)
  ds_write_b128 v88, v[48:51] offset:0
  s_waitcnt vmcnt(0)
  ds_write_b128 v88, v[52:55] offset:1024
  ds_read_b64_tr_b16 v[48:49], v89 offset:0
  ds_read_b64_tr_b16 v[50:51], v89 offset:64
  ds_read_b64_tr_b16 v[52:53], v89 offset:512
  ds_read_b64_tr_b16 v[54:55], v89 offset:576
  s_mov_b64 exec, 1
  ds_add_u32 v13, v12 offset:224
  s_mov_b64 exec, -1
  s_lshl_b32 s63, s68, 2
  s_add_u32 s63, s63, s3
  s_cmp_eq_u32 s63, 899
  s_cbranch_scc1 La_ep
La_noep:
  s_mov_b32 s65, 0
Lwo2:
  buffer_load_dwordx4 v90, s[20:23], s30 offen lds
  s_add_u32 m0, m0, 1024
  s_add_u32 s30, s30, 3584
  buffer_load_dwordx4 v90, s[20:23], s30 offen lds
  s_add_u32 m0, m0, 1024
  s_add_u32 s30, s30, 3584
  s_add_u32 s65, s65, 1
  s_waitcnt vmcnt(2)
  s_cmp_lt_u32 s65, 6
  s_cbranch_scc1 Lwo2
  s_lshl_b32 s63, s5, 2
  s_lshr_b32 s64, s4, 2
  s_add_u32 s63, s63, s64
  s_lshl_b32 s28, s63, 15
  s_lshl_b32 s64, s3, 13
  s_add_u32 s28, s28, s64
  s_add_u32 s28, s28, 5242880
  s_add_u32 s29, s28, 4096
  s_mul_i32 s30, s63, 57344
  s_lshl_b32 s63, s66, 8
  s_lshl_b32 s64, s3, 6
  s_add_u32 s63, s63, s64
  s_add_u32 s30, s30, s63
  s_mov_b32 s31, 0x3f800000
  s_waitcnt vmcnt(0)
  s_barrier
  s_waitcnt lgkmcnt(3)
  buffer_store_dwordx4 v[48:51], v2, s[24:27], 0 offen offset:0
  s_waitcnt lgkmcnt(1)
  buffer_store_dwordx4 v[52:55], v2, s[24:27], 0 offen offset:64
  s_barrier
  s_movk_i32 s65, 28672
  s_movk_i32 s41, 8192
  s_mul_i32 s64, s3, 28672
  v_add_u32 v84, s64, v84
  v_add_u32 v85, s64, v85
  v_add_u32 v86, s64, v86
  v_add_u32 v87, s64, v87
  ds_read_b64_tr_b16 v[128:129], v84 offset:0
  ds_read_b64_tr_b16 v[130:131], v85 offset:0
  ds_read_b64_tr_b16 v[132:133], v86 offset:0
  ds_read_b64_tr_b16 v[134:135], v87 offset:0
  ds_read_b64_tr_b16 v[136:137], v84 offset:7168
  ds_read_b64_tr_b16 v[138:139], v85 offset:7168
  ds_read_b64_tr_b16 v[140:141], v86 offset:7168
  ds_read_b64_tr_b16 v[142:143], v87 offset:7168
  ds_read_b64_tr_b16 v[144:145], v84 offset:14336
  ds_read_b64_tr_b16 v[146:147], v85 offset:14336
  ds_read_b64_tr_b16 v[148:149], v86 offset:14336
  ds_read_b64_tr_b16 v[150:151], v87 offset:14336
  ds_read_b64_tr_b16 v[152:153], v84 offset:21504
  ds_read_b64_tr_b16 v[154:155], v85 offset:21504
  ds_read_b64_tr_b16 v[156:157], v86 offset:21504
  ds_read_b64_tr_b16 v[158:159], v87 offset:21504
  s_cmp_eq_u32 s3, 3
  s_cselect_b32 s64, -86016, s65
  s_cselect_b32 s40, -24576, s41
  v_add_u32 v84, s64, v84
  v_add_u32 v85, s64, v85
  v_add_u32 v86, s64, v86
  v_add_u32 v87, s64, v87
  v_add_u32 v5, s40, v1
  ds_read_b64_tr_b16 v[160:161], v84 offset:0
  ds_read_b64_tr_b16 v[162:163], v85 offset:0
  ds_read_b64_tr_b16 v[164:165], v86 offset:0
  ds_read_b64_tr_b16 v[166:167], v87 offset:0
  ds_read_b64_tr_b16 v[168:169], v84 offset:7168
  ds_read_b64_tr_b16 v[170:171], v85 offset:7168
  ds_read_b64_tr_b16 v[172:173], v86 offset:7168
  ds_read_b64_tr_b16 v[174:175], v87 offset:7168
  ds_read_b64_tr_b16 v[176:177], v84 offset:14336
  ds_read_b64_tr_b16 v[178:179], v85 offset:14336
  ds_read_b64_tr_b16 v[180:181], v86 offset:14336
  ds_read_b64_tr_b16 v[182:183], v87 offset:14336
  ds_read_b64_tr_b16 v[184:185], v84 offset:21504
  ds_read_b64_tr_b16 v[186:187], v85 offset:21504
  ds_read_b64_tr_b16 v[188:189], v86 offset:21504
  ds_read_b64_tr_b16 v[190:191], v87 offset:21504
  s_cmp_eq_u32 s3, 2
  s_cselect_b32 s64, -86016, s65
  s_cselect_b32 s40, -24576, s41
  v_add_u32 v84, s64, v84
  v_add_u32 v85, s64, v85
  v_add_u32 v86, s64, v86
  v_add_u32 v87, s64, v87
  v_add_u32 v6, s40, v5
  ds_read_b64_tr_b16 v[192:193], v84 offset:0
  ds_read_b64_tr_b16 v[194:195], v85 offset:0
  ds_read_b64_tr_b16 v[196:197], v86 offset:0
  ds_read_b64_tr_b16 v[198:199], v87 offset:0
  ds_read_b64_tr_b16 v[200:201], v84 offset:7168
  ds_read_b64_tr_b16 v[202:203], v85 offset:7168
  ds_read_b64_tr_b16 v[204:205], v86 offset:7168
  ds_read_b64_tr_b16 v[206:207], v87 offset:7168
  ds_read_b64_tr_b16 v[208:209], v84 offset:14336
  ds_read_b64_tr_b16 v[210:211], v85 offset:14336
  ds_read_b64_tr_b16 v[212:213], v86 offset:14336
  ds_read_b64_tr_b16 v[214:215], v87 offset:14336
  ds_read_b64_tr_b16 v[216:217], v84 offset:21504
  ds_read_b64_tr_b16 v[218:219], v85 offset:21504
  ds_read_b64_tr_b16 v[220:221], v86 offset:21504
  ds_read_b64_tr_b16 v[222:223], v87 offset:21504
  s_cmp_eq_u32 s3, 1
  s_cselect_b32 s64, -86016, s65
  s_cselect_b32 s40, -24576, s41
  v_add_u32 v84, s64, v84
  v_add_u32 v85, s64, v85
  v_add_u32 v86, s64, v86
  v_add_u32 v87, s64, v87
  v_add_u32 v7, s40, v6
  ds_read_b64_tr_b16 v[224:225], v84 offset:0
  ds_read_b64_tr_b16 v[226:227], v85 offset:0
  ds_read_b64_tr_b16 v[228:229], v86 offset:0
  ds_read_b64_tr_b16 v[230:231], v87 offset:0
  ds_read_b64_tr_b16 v[232:233], v84 offset:7168
  ds_read_b64_tr_b16 v[234:235], v85 offset:7168
  ds_read_b64_tr_b16 v[236:237], v86 offset:7168
  ds_read_b64_tr_b16 v[238:239], v87 offset:7168
  ds_read_b64_tr_b16 v[240:241], v84 offset:14336
  ds_read_b64_tr_b16 v[242:243], v85 offset:14336
  ds_read_b64_tr_b16 v[244:245], v86 offset:14336
  ds_read_b64_tr_b16 v[246:247], v87 offset:14336
  ds_read_b64_tr_b16 v[248:249], v84 offset:21504
  ds_read_b64_tr_b16 v[250:251], v85 offset:21504
  ds_read_b64_tr_b16 v[252:253], v86 offset:21504
  ds_read_b64_tr_b16 v[254:255], v87 offset:21504
  s_waitcnt lgkmcnt(15)
  v_and_b32 v131, 0xffff, v131
  v_and_b32 v135, 0xffff, v135
  v_and_b32 v139, 0xffff, v139
  v_and_b32 v143, 0xffff, v143
  v_and_b32 v147, 0xffff, v147
  v_and_b32 v151, 0xffff, v151
  v_and_b32 v155, 0xffff, v155
  v_and_b32 v159, 0xffff, v159
  v_and_b32 v163, 0xffff, v163
  v_and_b32 v167, 0xffff, v167
  v_and_b32 v171, 0xffff, v171
  v_and_b32 v175, 0xffff, v175
  v_and_b32 v179, 0xffff, v179
  v_and_b32 v183, 0xffff, v183
  v_and_b32 v187, 0xffff, v187
  v_and_b32 v191, 0xffff, v191
  v_and_b32 v195, 0xffff, v195
  v_and_b32 v199, 0xffff, v199
  v_and_b32 v203, 0xffff, v203
  v_and_b32 v207, 0xffff, v207
  v_and_b32 v211, 0xffff, v211
  v_and_b32 v215, 0xffff, v215
  v_and_b32 v219, 0xffff, v219
  v_and_b32 v223, 0xffff, v223
  s_waitcnt lgkmcnt(14)
  v_and_b32 v227, 0xffff, v227
  s_waitcnt lgkmcnt(12)
  v_and_b32 v231, 0xffff, v231
  s_waitcnt lgkmcnt(10)
  v_and_b32 v235, 0xffff, v235
  s_waitcnt lgkmcnt(8)
  v_and_b32 v239, 0xffff, v239
  s_waitcnt lgkmcnt(6)
  v_and_b32 v243, 0xffff, v243
  s_waitcnt lgkmcnt(4)
  v_and_b32 v247, 0xffff, v247
  s_waitcnt lgkmcnt(2)
  v_and_b32 v251, 0xffff, v251
  s_waitcnt lgkmcnt(0)
  v_and_b32 v255, 0xffff, v255
  s_sleep 16
  s_mov_b32 s64, 0
Lop_54:
  buffer_load_dwordx4 v[16:19], v14, s[16:19], s28 offen offset:0 sc1
  buffer_load_dwordx4 v[20:23], v14, s[16:19], s28 offen offset:1024 sc1
  buffer_load_dwordx4 v[24:27], v14, s[16:19], s28 offen offset:2048 sc1
  buffer_load_dwordx4 v[28:31], v14, s[16:19], s28 offen offset:3072 sc1
  buffer_load_dwordx4 v[32:35], v14, s[16:19], s29 offen offset:0 sc1
  buffer_load_dwordx4 v[36:39], v14, s[16:19], s29 offen offset:1024 sc1
  buffer_load_dwordx4 v[40:43], v14, s[16:19], s29 offen offset:2048 sc1
  buffer_load_dwordx4 v[44:47], v14, s[16:19], s29 offen offset:3072 sc1
  s_add_u32 s64, s64, 1
  s_waitcnt vmcnt(0)
  v_min3_u32 v10, v19, v23, v27
  v_min3_u32 v11, v31, v35, v39
  v_min3_u32 v10, v10, v43, v47
  v_min_u32 v10, v10, v11
  v_cmp_gt_u32 vcc, s31, v10
  s_cbranch_vccz Lox_55
  s_cmp_lt_u32 s64, 200000
  s_cbranch_scc1 Lop_54
Lox_55:
  ds_write_b128 v1, v[16:19] offset:0
  ds_write_b128 v1, v[20:23] offset:1024
  ds_write_b128 v1, v[24:27] offset:2048
  v_mfma_f32_32x32x16_bf16 v[48:63], v[128:131], v[16:19], 0
  ds_write_b128 v1, v[28:31] offset:3072
  v_mfma_f32_32x32x16_bf16 v[48:63], v[132:135], v[20:23], v[48:63]
  ds_write_b128 v1, v[32:35] offset:4096
  v_mfma_f32_32x32x16_bf16 v[48:63], v[136:139], v[24:27], v[48:63]
  ds_write_b128 v1, v[36:39] offset:5120
  v_mfma_f32_32x32x16_bf16 v[48:63], v[140:143], v[28:31], v[48:63]
  ds_write_b128 v1, v[40:43] offset:6144
  v_mfma_f32_32x32x16_bf16 v[48:63], v[144:147], v[32:35], v[48:63]
  ds_write_b128 v1, v[44:47] offset:7168
  v_mfma_f32_32x32x16_bf16 v[48:63], v[148:151], v[36:39], v[48:63]
  s_waitcnt lgkmcnt(0)
  s_barrier
  s_cmp_ge_u32 s63, 896
  s_cbranch_scc1 La_end
  ds_read_b128 v[96:99], v5 offset:0
  ds_read_b128 v[100:103], v5 offset:1024
  ds_read_b128 v[104:107], v5 offset:2048
  v_mfma_f32_32x32x16_bf16 v[48:63], v[152:155], v[40:43], v[48:63]
  ds_read_b128 v[108:111], v5 offset:3072
  ds_read_b128 v[64:67], v5 offset:4096
  ds_read_b128 v[68:71], v5 offset:5120
  v_mfma_f32_32x32x16_bf16 v[48:63], v[156:159], v[44:47], v[48:63]
  ds_read_b128 v[72:75], v5 offset:6144
  ds_read_b128 v[76:79], v5 offset:7168
  ds_read_b128 v[80:83], v6 offset:0
  ds_read_b128 v[84:87], v6 offset:1024
  ds_read_b128 v[88:91], v6 offset:2048
  s_waitcnt lgkmcnt(10)
  v_mfma_f32_32x32x16_bf16 v[48:63], v[160:163], v[96:99], v[48:63]
  ds_read_b128 v[92:95], v6 offset:3072
  s_waitcnt lgkmcnt(10)
  v_mfma_f32_32x32x16_bf16 v[48:63], v[164:167], v[100:103], v[48:63]
  ds_read_b128 v[96:99], v6 offset:4096
  s_waitcnt lgkmcnt(10)
  v_mfma_f32_32x32x16_bf16 v[48:63], v[168:171], v[104:107], v[48:63]
  ds_read_b128 v[100:103], v6 offset:5120
  s_waitcnt lgkmcnt(10)
  v_mfma_f32_32x32x16_bf16 v[48:63], v[172:175], v[108:111], v[48:63]
  ds_read_b128 v[104:107], v6 offset:6144
  s_waitcnt lgkmcnt(10)
  v_mfma_f32_32x32x16_bf16 v[48:63], v[176:179], v[64:67], v[48:63]
  ds_read_b128 v[108:111], v6 offset:7168
  s_waitcnt lgkmcnt(10)
  v_mfma_f32_32x32x16_bf16 v[48:63], v[180:183], v[68:71], v[48:63]
  ds_read_b128 v[64:67], v7 offset:0
  s_waitcnt lgkmcnt(10)
  v_mfma_f32_32x32x16_bf16 v[48:63], v[184:187], v[72:75], v[48:63]
  ds_read_b128 v[68:71], v7 offset:1024
  s_waitcnt lgkmcnt(10)
  v_mfma_f32_32x32x16_bf16 v[48:63], v[188:191], v[76:79], v[48:63]
  ds_read_b128 v[72:75], v7 offset:2048
  s_waitcnt lgkmcnt(10)
  v_mfma_f32_32x32x16_bf16 v[48:63], v[192:195], v[80:83], v[48:63]
  ds_read_b128 v[76:79], v7 offset:3072
  s_waitcnt lgkmcnt(10)
  v_mfma_f32_32x32x16_bf16 v[48:63], v[196:199], v[84:87], v[48:63]
  ds_read_b128 v[80:83], v7 offset:4096
  s_waitcnt lgkmcnt(10)
  v_mfma_f32_32x32x16_bf16 v[48:63], v[200:203], v[88:91], v[48:63]
  ds_read_b128 v[84:87], v7 offset:5120
  s_waitcnt lgkmcnt(10)
  v_mfma_f32_32x32x16_bf16 v[48:63], v[204:207], v[92:95], v[48:63]
  ds_read_b128 v[88:91], v7 offset:6144
  s_waitcnt lgkmcnt(10)
  v_mfma_f32_32x32x16_bf16 v[48:63], v[208:211], v[96:99], v[48:63]
  ds_read_b128 v[92:95], v7 offset:7168
  s_waitcnt lgkmcnt(10)
  v_mfma_f32_32x32x16_bf16 v[48:63], v[212:215], v[100:103], v[48:63]
  s_waitcnt lgkmcnt(9)
  v_mfma_f32_32x32x16_bf16 v[48:63], v[216:219], v[104:107], v[48:63]
  s_waitcnt lgkmcnt(8)
  v_mfma_f32_32x32x16_bf16 v[48:63], v[220:223], v[108:111], v[48:63]
  s_waitcnt lgkmcnt(7)
  v_mfma_f32_32x32x16_bf16 v[48:63], v[224:227], v[64:67], v[48:63]
  s_waitcnt lgkmcnt(6)
  v_mfma_f32_32x32x16_bf16 v[48:63], v[228:231], v[68:71], v[48:63]
  s_waitcnt lgkmcnt(5)
  v_mfma_f32_32x32x16_bf16 v[48:63], v[232:235], v[72:75], v[48:63]
  s_waitcnt lgkmcnt(4)
  v_mfma_f32_32x32x16_bf16 v[48:63], v[236:239], v[76:79], v[48:63]
  s_waitcnt lgkmcnt(3)
  v_mfma_f32_32x32x16_bf16 v[48:63], v[240:243], v[80:83], v[48:63]
  s_waitcnt lgkmcnt(2)
  v_mfma_f32_32x32x16_bf16 v[48:63], v[244:247], v[84:87], v[48:63]
  s_waitcnt lgkmcnt(1)
  v_mfma_f32_32x32x16_bf16 v[48:63], v[248:251], v[88:91], v[48:63]
  s_waitcnt lgkmcnt(0)
  v_mfma_f32_32x32x16_bf16 v[48:63], v[252:255], v[92:95], v[48:63]
  s_nop 11
  v_cvt_pk_bf16_f32 v112, v48, v49
  v_cvt_pk_bf16_f32 v113, v50, v51
  v_cvt_pk_bf16_f32 v114, v52, v53
  v_cvt_pk_bf16_f32 v115, v54, v55
  buffer_store_dwordx4 v[112:115], v3, s[24:27], s30 offen offset:896
  v_cvt_pk_bf16_f32 v116, v56, v57
  v_cvt_pk_bf16_f32 v117, v58, v59
  v_cvt_pk_bf16_f32 v118, v60, v61
  v_cvt_pk_bf16_f32 v119, v62, v63
  buffer_store_dwordx4 v[116:119], v3, s[24:27], s30 offen offset:928
La_end:
  s_endpgm
  .p2align 12
La_t:
  s_setprio 3
  s_sub_u32 s24, s7, 28
  s_lshl2_add_u32 s24, s24, s3
  s_waitcnt lgkmcnt(0)
  s_mul_i32 s46, s24, 114688
  s_mul_i32 s64, s6, 128
  s_add_u32 s46, s46, s64
  s_lshl2_add_u32 s68, s6, s7
  s_add_u32 s68, s68, 196
  v_bfe_u32 v3, v0, 4, 1
  v_xor_b32 v2, v2, v3
  v_mul_u32_u24 v1, 896, v1
  v_xor_b32 v3, 0, v2
  v_lshl_add_u32 v80, v3, 4, v1
  v_xor_b32 v3, 2, v2
  v_lshl_add_u32 v81, v3, 4, v1
  v_xor_b32 v3, 4, v2
  v_lshl_add_u32 v82, v3, 4, v1
  v_xor_b32 v3, 6, v2
  v_lshl_add_u32 v83, v3, 4, v1
  s_waitcnt lgkmcnt(0)
  s_mov_b32 s8, s32
  s_mov_b32 s9, s33
  s_load_dword s62, s[60:61], 0
  s_mul_i32 s67, s3, 8704
  s_add_u32 s67, s67, 106496
  s_lshl_b32 s47, s3, 12
  s_add_u32 s47, s47, 137216
  s_cmp_eq_u32 s6, 7
  s_cbranch_scc1 Lt_nl
  s_add_u32 m0, s67, 0
  s_add_u32 s45, s46, 0
  buffer_load_dwordx4 v80, s[8:11], s45 offen lds
  s_add_u32 m0, s67, 1024
  s_add_u32 s45, s46, 7168
  buffer_load_dwordx4 v80, s[8:11], s45 offen lds
  s_add_u32 m0, s67, 2048
  s_add_u32 s45, s46, 14336
  buffer_load_dwordx4 v81, s[8:11], s45 offen lds
  s_add_u32 m0, s67, 3072
  s_add_u32 s45, s46, 21504
  buffer_load_dwordx4 v81, s[8:11], s45 offen lds
  s_add_u32 m0, s47, 4096
  s_add_u32 s45, s46, 28672
  buffer_load_dwordx4 v82, s[8:11], s45 offen lds
  s_add_u32 m0, s47, 5120
  s_add_u32 s45, s46, 35840
  buffer_load_dwordx4 v82, s[8:11], s45 offen lds
  s_add_u32 m0, s47, 6144
  s_add_u32 s45, s46, 43008
  buffer_load_dwordx4 v83, s[8:11], s45 offen lds
  s_add_u32 m0, s47, 7168
  s_add_u32 s45, s46, 50176
  buffer_load_dwordx4 v83, s[8:11], s45 offen lds
  s_add_u32 s45, s46, 57344
  buffer_load_dwordx4 v[128:131], v80, s[8:11], s45 offen
  s_add_u32 s45, s46, 64512
  buffer_load_dwordx4 v[132:135], v80, s[8:11], s45 offen
  s_add_u32 s45, s46, 71680
  buffer_load_dwordx4 v[136:139], v81, s[8:11], s45 offen
  s_add_u32 s45, s46, 78848
  buffer_load_dwordx4 v[140:143], v81, s[8:11], s45 offen
  s_add_u32 s45, s46, 86016
  buffer_load_dwordx4 v[144:147], v82, s[8:11], s45 offen
  s_add_u32 s45, s46, 93184
  buffer_load_dwordx4 v[148:151], v82, s[8:11], s45 offen
  s_add_u32 s45, s46, 100352
  buffer_load_dwordx4 v[152:155], v83, s[8:11], s45 offen
  s_add_u32 s45, s46, 107520
  buffer_load_dwordx4 v[156:159], v83, s[8:11], s45 offen
Lt_nl:
Lt_hr:
  v_lshlrev_b32 v14, 4, v0
  v_add_u32 v2, s67, v14
  s_mov_b32 s16, s60
  s_mov_b32 s17, s61
  s_mov_b32 s18, 16777216
  s_mov_b32 s19, 0x20000
  v_mov_b32 v12, 1
  v_mov_b32 v17, 0
  v_mov_b32 v18, 0
  v_mov_b32 v19, 0
  s_waitcnt lgkmcnt(0)
  s_mul_i32 s62, s62, 0x9E3779B1
  s_add_u32 s62, s62, 0x7F4A7C15
  s_or_b32 s62, s62, 1
  v_mov_b32 v7, s62
  v_lshrrev_b32 v1, 4, v0
  s_cmp_eq_u32 s6, 7
  s_cbranch_scc1 Lt_done
  v_and_b32 v3, 15, v0
  v_mul_u32_u24 v4, 20608, v1
  v_lshl_add_u32 v84, v3, 4, v4
  v_lshl_add_u32 v85, v3, 3, v4
  v_add_u32 v3, s47, v14
  v_mov_b32 v6, s47
  s_mov_b32 exec_lo, 0x33333333
  s_mov_b32 exec_hi, 0x33333333
  v_mov_b32 v6, s67
  s_mov_b64 exec, -1
  v_and_b32 v4, 3, v0
  v_lshl_add_u32 v6, v4, 11, v6
  v_bfe_u32 v5, v0, 3, 1
  v_lshl_add_u32 v4, v4, 1, v5
  v_lshlrev_b32 v4, 1, v4
  v_xor_b32 v4, v4, v1
  v_bfe_u32 v5, v0, 2, 2
  v_lshl_add_u32 v6, v5, 7, v6
  v_xor_b32 v5, 0, v4
  v_lshl_add_u32 v88, v5, 3, v6
  v_xor_b32 v5, 4, v4
  v_lshl_add_u32 v89, v5, 3, v6
  v_xor_b32 v5, 8, v4
  v_lshl_add_u32 v90, v5, 3, v6
  v_xor_b32 v5, 12, v4
  v_lshl_add_u32 v91, v5, 3, v6
  s_mul_i32 s63, s6, 329728
  s_mul_i32 s41, s24, 1280
  s_add_u32 s41, s41, s63
  s_add_u32 s41, s41, 8388608
  s_mov_b32 s53, s41
  s_mov_b32 s40, 1
  s_setprio 3
  s_waitcnt vmcnt(8)
Lt_body:
  ds_read_b64_tr_b16 v[192:193], v88 offset:0
  ds_read_b64_tr_b16 v[194:195], v88 offset:512
  ds_read_b64_tr_b16 v[196:197], v88 offset:1024
  ds_read_b64_tr_b16 v[198:199], v88 offset:1536
  ds_read_b64_tr_b16 v[200:201], v89 offset:0
  ds_read_b64_tr_b16 v[202:203], v89 offset:512
  ds_read_b64_tr_b16 v[204:205], v89 offset:1024
  ds_read_b64_tr_b16 v[206:207], v89 offset:1536
  ds_read_b64_tr_b16 v[208:209], v90 offset:0
  ds_read_b64_tr_b16 v[210:211], v90 offset:512
  ds_read_b64_tr_b16 v[212:213], v90 offset:1024
  ds_read_b64_tr_b16 v[214:215], v90 offset:1536
  ds_read_b64_tr_b16 v[216:217], v91 offset:0
  ds_read_b64_tr_b16 v[218:219], v91 offset:512
  ds_read_b64_tr_b16 v[220:221], v91 offset:1024
  ds_read_b64_tr_b16 v[222:223], v91 offset:1536
  s_waitcnt lgkmcnt(14)
  buffer_store_dwordx4 v[192:195], v84, s[16:19], s53 offen offset:0
  v_lshl_add_u32 v20, v192, 1, v193
  v_lshl_add_u32 v20, v20, 1, v194
  v_lshl_add_u32 v20, v20, 1, v195
  v_xor_b32 v20, s62, v20
  s_waitcnt lgkmcnt(12)
  buffer_store_dwordx4 v[196:199], v84, s[16:19], s53 offen offset:256
  v_lshl_add_u32 v21, v196, 1, v197
  v_lshl_add_u32 v21, v21, 1, v198
  v_lshl_add_u32 v21, v21, 1, v199
  v_xor_b32 v21, s62, v21
  buffer_store_dwordx2 v[20:21], v85, s[16:19], s53 offen offset:512
  s_add_u32 s53, s53, 82432
  s_waitcnt lgkmcnt(10)
  buffer_store_dwordx4 v[200:203], v84, s[16:19], s53 offen offset:0
  v_lshl_add_u32 v22, v200, 1, v201
  v_lshl_add_u32 v22, v22, 1, v202
  v_lshl_add_u32 v22, v22, 1, v203
  v_xor_b32 v22, s62, v22
  s_waitcnt lgkmcnt(8)
  buffer_store_dwordx4 v[204:207], v84, s[16:19], s53 offen offset:256
  v_lshl_add_u32 v23, v204, 1, v205
  v_lshl_add_u32 v23, v23, 1, v206
  v_lshl_add_u32 v23, v23, 1, v207
  v_xor_b32 v23, s62, v23
  buffer_store_dwordx2 v[22:23], v85, s[16:19], s53 offen offset:512
  s_add_u32 s53, s53, 82432
  s_waitcnt lgkmcnt(6)
  buffer_store_dwordx4 v[208:211], v84, s[16:19], s53 offen offset:0
  v_lshl_add_u32 v24, v208, 1, v209
  v_lshl_add_u32 v24, v24, 1, v210
  v_lshl_add_u32 v24, v24, 1, v211
  v_xor_b32 v24, s62, v24
  s_waitcnt lgkmcnt(4)
  buffer_store_dwordx4 v[212:215], v84, s[16:19], s53 offen offset:256
  v_lshl_add_u32 v25, v212, 1, v213
  v_lshl_add_u32 v25, v25, 1, v214
  v_lshl_add_u32 v25, v25, 1, v215
  v_xor_b32 v25, s62, v25
  buffer_store_dwordx2 v[24:25], v85, s[16:19], s53 offen offset:512
  s_add_u32 s53, s53, 82432
  s_waitcnt lgkmcnt(2)
  buffer_store_dwordx4 v[216:219], v84, s[16:19], s53 offen offset:0 sc1
  v_lshl_add_u32 v26, v216, 1, v217
  v_lshl_add_u32 v26, v26, 1, v218
  v_lshl_add_u32 v26, v26, 1, v219
  v_xor_b32 v26, s62, v26
  s_waitcnt lgkmcnt(0)
  buffer_store_dwordx4 v[220:223], v84, s[16:19], s53 offen offset:256 sc1
  v_lshl_add_u32 v27, v220, 1, v221
  v_lshl_add_u32 v27, v27, 1, v222
  v_lshl_add_u32 v27, v27, 1, v223
  v_xor_b32 v27, s62, v27
  buffer_store_dwordx2 v[26:27], v85, s[16:19], s53 offen offset:512 sc1
  s_add_u32 s53, s53, 4294720640
  s_mov_b64 exec, -1
  s_add_u32 s40, s40, 1
  s_cmp_eq_u32 s40, 3
  s_cbranch_scc1 Lt_done
  s_waitcnt vmcnt(12)
  ds_write_b128 v2, v[128:131] offset:0
  ds_write_b128 v2, v[132:135] offset:1024
  ds_write_b128 v2, v[136:139] offset:2048
  ds_write_b128 v2, v[140:143] offset:3072
  ds_write_b128 v3, v[144:147] offset:4096
  ds_write_b128 v3, v[148:151] offset:5120
  ds_write_b128 v3, v[152:155] offset:6144
  ds_write_b128 v3, v[156:159] offset:7168
  s_branch Lt_body
Lt_done:
  s_setprio 0
  s_mov_b32 s64, 0
Lsp_19:
  ds_read_b32 v5, v13 offset:48
  s_add_u32 s64, s64, 1
  s_waitcnt lgkmcnt(0)
  v_readfirstlane_b32 s65, v5
  s_cmp_ge_u32 s65, 4
  s_cbranch_scc1 Lsx_20
  s_sleep 8
  s_cmp_lt_u32 s64, 200000
  s_cbranch_scc1 Lsp_19
Lsx_20:
  ds_read_b128 v[8:11], v2 offset:4096
  ds_read_b128 v[84:87], v2 offset:5120
  ds_read_b128 v[88:91], v2 offset:6144
  ds_read_b128 v[0:3], v2 offset:7168
  s_and_b32 s66, s4, 3
  s_mov_b32 s69, 0x8000
  s_mov_b32 s24, s56
  s_mov_b32 s25, s57
  s_mov_b32 s26, 3670016
  s_mov_b32 s27, 0x20000
  s_mov_b32 s20, s54
  s_mov_b32 s21, s55
  s_mov_b32 s22, 401408
  s_mov_b32 s23, 0x20000
  s_waitcnt lgkmcnt(3)
  buffer_store_dwordx4 v[16:19], v9, s[16:19], 0 offen sc1
  buffer_store_dwordx4 v[16:19], v9, s[16:19], 0 offen offset:1024 sc1
  s_branch La_pub
Lkv_t:
  s_waitcnt vmcnt(10)
  ds_read_b128 v[208:211], v5 offset:4096
  ds_read_b128 v[212:215], v6 offset:4096
  ds_read_b128 v[216:219], v7 offset:4096
  ds_read_b128 v[220:223], v8 offset:4096
  s_waitcnt lgkmcnt(0)
  s_add_u32 m0, s25, 4096
  s_nop 0
  buffer_load_dwordx4 v16, s[12:15], s27 offen lds
  s_add_u32 s27, s27, 43008
  s_add_u32 m0, s25, 5120
  s_nop 0
  buffer_load_dwordx4 v16, s[12:15], s27 offen lds
  s_add_u32 s27, s27, 43008
  s_add_u32 m0, s25, 6144
  s_nop 0
  buffer_load_dwordx4 v16, s[12:15], s27 offen lds
  s_add_u32 s27, s27, 43008
  s_add_u32 m0, s25, 7168
  s_nop 0
  buffer_load_dwordx4 v16, s[12:15], s27 offen lds
  s_add_u32 s27, s27, 43008
  s_waitcnt vmcnt(8)
  s_mov_b64 exec, 1
  ds_add_u32 v13, v12 offset:64
  s_mov_b64 exec, -1
  ds_read_b128 v[224:227], v5 offset:8192
  ds_read_b128 v[228:231], v6 offset:8192
  ds_read_b128 v[232:235], v7 offset:8192
  ds_read_b128 v[236:239], v8 offset:8192
  s_waitcnt lgkmcnt(0)
  s_add_u32 m0, s25, 8192
  s_nop 0
  buffer_load_dwordx4 v16, s[12:15], s27 offen lds
  s_add_u32 s27, s27, 43008
  s_add_u32 m0, s25, 9216
  s_nop 0
  buffer_load_dwordx4 v16, s[12:15], s27 offen lds
  s_add_u32 s27, s27, 43008
  s_add_u32 m0, s25, 10240
  s_nop 0
  buffer_load_dwordx4 v16, s[12:15], s27 offen lds
  s_waitcnt vmcnt(7)
  ds_read_b128 v[240:243], v5 offset:0
  ds_read_b128 v[244:247], v6 offset:0
  ds_read_b128 v[248:251], v7 offset:0
  ds_read_b128 v[252:255], v8 offset:0
  s_waitcnt lgkmcnt(0)
  s_mov_b32 s34, 0x40000000
  s_waitcnt vmcnt(0)
  s_mov_b64 exec, 1
  ds_add_u32 v13, v12 offset:16
  s_mov_b64 exec, -1
  ds_read_b32 v23, v13 offset:16
  s_branch Lkv_done
Lslow0:
  s_mov_b32 s64, 0
Lsl0:
  buffer_load_dword v31, v22, s[16:19], 0 offen sc1
  s_add_u32 s64, s64, 1
  s_waitcnt vmcnt(0)
  v_cmp_eq_u32 vcc, s62, v31
  s_and_b32 s35, vcc_lo, vcc_hi
  s_lshr_b32 s63, s35, 16
  s_and_b32 s35, s35, s63
  s_cmp_eq_u32 s35, 0xffff
  s_cselect_b32 s35, -1, s35
  s_and_b32 s37, s36, s35
  s_cbranch_scc1 Lsr0
  s_sleep 2
  s_cmp_lt_u32 s64, 200000
  s_cbranch_scc1 Lsl0
  s_mov_b32 s37, s36
  s_branch Lsr0
Lslow1:
  s_mov_b32 s64, 0
Lsl1:
  buffer_load_dword v31, v22, s[16:19], 0 offen sc1
  s_add_u32 s64, s64, 1
  s_waitcnt vmcnt(0)
  v_cmp_eq_u32 vcc, s62, v31
  s_and_b32 s35, vcc_lo, vcc_hi
  s_lshr_b32 s63, s35, 16
  s_and_b32 s35, s35, s63
  s_cmp_eq_u32 s35, 0xffff
  s_cselect_b32 s35, -1, s35
  s_and_b32 s37, s36, s35
  s_cbranch_scc1 Lsr1
  s_sleep 2
  s_cmp_lt_u32 s64, 200000
  s_cbranch_scc1 Lsl1
  s_mov_b32 s37, s36
  s_branch Lsr1
Lslow2:
  s_mov_b32 s64, 0
Lsl2:
  buffer_load_dword v31, v22, s[16:19], 0 offen sc1
  s_add_u32 s64, s64, 1
  s_waitcnt vmcnt(0)
  v_cmp_eq_u32 vcc, s62, v31
  s_and_b32 s35, vcc_lo, vcc_hi
  s_lshr_b32 s63, s35, 16
  s_and_b32 s35, s35, s63
  s_cmp_eq_u32 s35, 0xffff
  s_cselect_b32 s35, -1, s35
  s_and_b32 s37, s36, s35
  s_cbranch_scc1 Lsr2
  s_sleep 2
  s_cmp_lt_u32 s64, 200000
  s_cbranch_scc1 Lsl2
  s_mov_b32 s37, s36
  s_branch Lsr2
Lslow3:
  s_mov_b32 s64, 0
Lsl3:
  buffer_load_dword v31, v22, s[16:19], 0 offen sc1
  s_add_u32 s64, s64, 1
  s_waitcnt vmcnt(0)
  v_cmp_eq_u32 vcc, s62, v31
  s_and_b32 s35, vcc_lo, vcc_hi
  s_lshr_b32 s63, s35, 16
  s_and_b32 s35, s35, s63
  s_cmp_eq_u32 s35, 0xffff
  s_cselect_b32 s35, -1, s35
  s_and_b32 s37, s36, s35
  s_cbranch_scc1 Lsr3
  s_sleep 2
  s_cmp_lt_u32 s64, 200000
  s_cbranch_scc1 Lsl3
  s_mov_b32 s37, s36
  s_branch Lsr3
Lslow4:
  s_mov_b32 s64, 0
Lsl4:
  buffer_load_dword v31, v22, s[16:19], 0 offen sc1
  s_add_u32 s64, s64, 1
  s_waitcnt vmcnt(0)
  v_cmp_eq_u32 vcc, s62, v31
  s_and_b32 s35, vcc_lo, vcc_hi
  s_lshr_b32 s63, s35, 16
  s_and_b32 s35, s35, s63
  s_cmp_eq_u32 s35, 0xffff
  s_cselect_b32 s35, -1, s35
  s_and_b32 s37, s36, s35
  s_cbranch_scc1 Lsr4
  s_sleep 2
  s_cmp_lt_u32 s64, 200000
  s_cbranch_scc1 Lsl4
  s_mov_b32 s37, s36
  s_branch Lsr4
Lfallback:
  v_mov_b32 v23, 0xff800000
  s_mov_b32 s28, 0
  s_mov_b32 s29, 0
Lfb1:
  buffer_load_dwordx4 v[192:195], v24, s[20:23], s28 offen sc1
  buffer_load_dwordx4 v[196:199], v24, s[20:23], s28 offen offset:1024 sc1
  s_add_u32 s28, s28, 59136
  s_add_u32 s29, s29, 1
  s_waitcnt vmcnt(0)
  v_mfma_f32_32x32x16_bf16 v[128:143], v[192:195], v[56:59], 0
  v_mfma_f32_32x32x16_bf16 v[128:143], v[196:199], v[60:63], v[128:143]
  s_nop 11
  v_max3_f32 v23, v23, v128, v129
  v_max3_f32 v23, v23, v130, v131
  v_max3_f32 v23, v23, v132, v133
  v_max3_f32 v23, v23, v134, v135
  v_max3_f32 v23, v23, v136, v137
  v_max3_f32 v23, v23, v138, v139
  v_max3_f32 v23, v23, v140, v141
  v_max3_f32 v23, v23, v142, v143
  s_cmp_lt_u32 s29, 64
  s_cbranch_scc1 Lfb1
  v_mov_b32 v22, v23
  s_nop 1
  v_permlane32_swap_b32 v22, v23
  v_max_f32 v23, v22, v23
  v_mov_b32 v112, 0
  v_mov_b32 v113, 0
  v_mov_b32 v114, 0
  v_mov_b32 v115, 0
  v_mov_b32 v116, 0
  v_mov_b32 v117, 0
  v_mov_b32 v118, 0
  v_mov_b32 v119, 0
  v_mov_b32 v120, 0
  v_mov_b32 v121, 0
  v_mov_b32 v122, 0
  v_mov_b32 v123, 0
  v_mov_b32 v124, 0
  v_mov_b32 v125, 0
  v_mov_b32 v126, 0
  v_mov_b32 v127, 0
  s_mov_b32 s28, 0
  s_mov_b32 s29, 0
Lfb2:
  s_add_u32 s30, s28, 15232
  buffer_load_dwordx4 v[192:195], v24, s[20:23], s28 offen offset:0 sc1
  buffer_load_dwordx4 v[196:199], v24, s[20:23], s28 offen offset:1024 sc1
  buffer_load_dwordx4 v[200:203], v30, s[20:23], s28 offen sc1
  buffer_load_dwordx4 v[204:207], v30, s[20:23], s30 offen sc1
  s_add_u32 s28, s28, 59136
  s_add_u32 s29, s29, 1
  s_waitcnt vmcnt(0)
  v_mfma_f32_32x32x16_bf16 v[128:143], v[192:195], v[56:59], 0
  v_mfma_f32_32x32x16_bf16 v[128:143], v[196:199], v[60:63], v[128:143]
  s_nop 11
  v_sub_f32 v128, v128, v23
  v_sub_f32 v129, v129, v23
  v_sub_f32 v130, v130, v23
  v_sub_f32 v131, v131, v23
  v_sub_f32 v132, v132, v23
  v_sub_f32 v133, v133, v23
  v_sub_f32 v134, v134, v23
  v_sub_f32 v135, v135, v23
  v_sub_f32 v136, v136, v23
  v_sub_f32 v137, v137, v23
  v_sub_f32 v138, v138, v23
  v_sub_f32 v139, v139, v23
  v_sub_f32 v140, v140, v23
  v_sub_f32 v141, v141, v23
  v_sub_f32 v142, v142, v23
  v_sub_f32 v143, v143, v23
  v_exp_f32 v128, v128
  v_exp_f32 v129, v129
  v_exp_f32 v130, v130
  v_exp_f32 v131, v131
  v_exp_f32 v132, v132
  v_exp_f32 v133, v133
  v_exp_f32 v134, v134
  v_exp_f32 v135, v135
  v_exp_f32 v136, v136
  v_exp_f32 v137, v137
  v_exp_f32 v138, v138
  v_exp_f32 v139, v139
  v_exp_f32 v140, v140
  v_exp_f32 v141, v141
  v_exp_f32 v142, v142
  v_exp_f32 v143, v143
  v_smfmac_f32_32x32x32_bf16 v[112:127], v[200:203], v[128:135], v9
  s_nop 0
  v_smfmac_f32_32x32x32_bf16 v[112:127], v[204:207], v[136:143], v9
  s_nop 7
  s_cmp_lt_u32 s29, 64
  s_cbranch_scc1 Lfb2
  s_nop 11
  v_rcp_f32 v64, v119
  s_nop 0
  s_branch Lnorm
La_ug:
  s_mov_b32 s8, s32
  s_mov_b32 s9, s33
  v_lshrrev_b32 v4, 1, v0
  v_mul_u32_u24 v4, 14336, v4
  v_and_b32 v5, 1, v0
  v_lshl_add_u32 v4, v5, 1, v4
  s_mul_i32 s63, s3, 458752
  s_lshl2_add_u32 s63, s68, s63
  buffer_load_ushort v32, v4, s[8:11], s63 offen
  s_add_u32 s63, s63, 896
  buffer_load_ushort v33, v4, s[8:11], s63 offen
  s_add_u32 s63, s63, 896
  buffer_load_ushort v34, v4, s[8:11], s63 offen
  s_add_u32 s63, s63, 896
  buffer_load_ushort v35, v4, s[8:11], s63 offen
  s_add_u32 s63, s63, 896
  buffer_load_ushort v36, v4, s[8:11], s63 offen
  s_add_u32 s63, s63, 896
  buffer_load_ushort v37, v4, s[8:11], s63 offen
  s_add_u32 s63, s63, 896
  buffer_load_ushort v38, v4, s[8:11], s63 offen
  s_add_u32 s63, s63, 896
  buffer_load_ushort v39, v4, s[8:11], s63 offen
  s_add_u32 s63, s63, 896
  buffer_load_ushort v40, v4, s[8:11], s63 offen
  s_add_u32 s63, s63, 896
  buffer_load_ushort v41, v4, s[8:11], s63 offen
  s_add_u32 s63, s63, 896
  buffer_load_ushort v42, v4, s[8:11], s63 offen
  s_add_u32 s63, s63, 896
  buffer_load_ushort v43, v4, s[8:11], s63 offen
  s_add_u32 s63, s63, 896
  buffer_load_ushort v44, v4, s[8:11], s63 offen
  s_add_u32 s63, s63, 896
  buffer_load_ushort v45, v4, s[8:11], s63 offen
  s_add_u32 s63, s63, 896
  buffer_load_ushort v46, v4, s[8:11], s63 offen
  s_add_u32 s63, s63, 896
  buffer_load_ushort v47, v4, s[8:11], s63 offen
  s_add_u32 s63, s63, 896
  s_waitcnt vmcnt(14)
  v_lshl_or_b32 v88, v33, 16, v32
  s_waitcnt vmcnt(12)
  v_lshl_or_b32 v89, v35, 16, v34
  s_waitcnt vmcnt(10)
  v_lshl_or_b32 v90, v37, 16, v36
  s_waitcnt vmcnt(8)
  v_lshl_or_b32 v91, v39, 16, v38
  s_waitcnt vmcnt(6)
  v_lshl_or_b32 v92, v41, 16, v40
  s_waitcnt vmcnt(4)
  v_lshl_or_b32 v93, v43, 16, v42
  s_waitcnt vmcnt(2)
  v_lshl_or_b32 v94, v45, 16, v44
  s_waitcnt vmcnt(0)
  v_lshl_or_b32 v95, v47, 16, v46
  s_branch La_ux
La_ep:
  v_lshlrev_b32 v96, 3, v14
  v_add_u32 v96, 131072, v96
  v_add_u32 v97, 8192, v96
  v_add_u32 v98, 8192, v97
  v_add_u32 v99, 8192, v98
  s_mov_b32 s64, 0
Lpf_51:
  buffer_load_dword v20, v96, s[16:19], 0 offen sc1
  buffer_load_dword v21, v97, s[16:19], 0 offen sc1
  buffer_load_dword v22, v98, s[16:19], 0 offen sc1
  buffer_load_dword v23, v99, s[16:19], 0 offen sc1
Lpe_53:
  s_add_u32 s64, s64, 1
  s_waitcnt vmcnt(0)
  v_xor_b32 v20, s62, v20
  v_xor_b32 v21, s62, v21
  v_or_b32 v20, v20, v21
  v_xor_b32 v22, s62, v22
  v_or_b32 v20, v20, v22
  v_xor_b32 v23, s62, v23
  v_or_b32 v20, v20, v23
  v_cmp_ne_u32 vcc, 0, v20
  s_cbranch_vccz Lpx_52
  s_sleep 4
  s_cmp_lt_u32 s64, 200000
  s_cbranch_scc1 Lpf_51
Lpx_52:
  s_mov_b64 exec, 1
  buffer_store_dword v7, v16, s[16:19], 0 offen sc1
  s_mov_b64 exec, -1
  s_branch La_noep
.section .rodata,"a"
.p2align 6
.amdhsa_kernel concat_heads__ssm_conv_s4__softmax_full_mha__prompt_kernel
  .amdhsa_next_free_vgpr 256
  .amdhsa_next_free_sgpr 102
  .amdhsa_accum_offset 256
  .amdhsa_group_segment_fixed_size 0
  .amdhsa_kernarg_size 120
  .amdhsa_user_sgpr_count 2
  .amdhsa_user_sgpr_kernarg_segment_ptr 1
  .amdhsa_system_sgpr_workgroup_id_x 1
.end_amdhsa_kernel
```
